```python
import torch

def _softmax(x, axis=-1):
    return torch.softmax(x, dim=axis)
def _gelu(x):
    return torch.nn.functional.gelu(x, approximate="tanh")
def _silu(x):
    return torch.nn.functional.silu(x)
def _sigmoid(x):
    return torch.sigmoid(x)
def _layernorm(x, axis=-1, eps=1e-5):
    m = x.mean(dim=axis, keepdim=True)
    v = x.var(dim=axis, keepdim=True, unbiased=False)
    return (x - m) / torch.sqrt(v + eps)
def _scatter_add(tgt, idx, src, axis=0):
    return tgt.clone().index_add_(axis, idx, src)
def _segment_sum(src, seg, n):
    out = torch.zeros((n,) + src.shape[1:], dtype=src.dtype)
    return out.index_add_(0, seg, src)
def _pad(x, pw):
    flat = tuple(v for pair in reversed(pw) for v in pair)
    return torch.nn.functional.pad(x, flat)

kernel_name = 'parallel_sum__ssm_conv_s4d__glu_gated_swiglu__prompt'

def setup_inputs():

    _w = (lambda a: (lambda t: t.to(torch.bfloat16) if t.is_floating_point() else t)(torch.as_tensor(a)))
    def _A_setup():
        Bsz, L, D, N = 1, 2048, 640, 192
        return {
            "u": _w((lambda *s: torch.randn(*s, dtype=torch.bfloat16) * 0.05)(Bsz, L, D)),
            "log_A_real": _w((lambda *s: torch.randn(*s, dtype=torch.bfloat16) * 3.2)(D, N) * 0.5),
            "A_imag": _w((lambda *s: torch.randn(*s, dtype=torch.bfloat16) * 0.05)(D, N) * 3.14),
            "C_real": _w((lambda *s: torch.randn(*s, dtype=torch.bfloat16) * 0.2)(D, N) / N ** 0.5),
            "C_imag": _w((lambda *s: torch.randn(*s, dtype=torch.bfloat16) * 0.2)(D, N) / N ** 0.5),
            "log_dt": _w((lambda *s: torch.randn(*s, dtype=torch.bfloat16) * 0.05)(D) * 0.5 - 4.0),
            "D_skip": _w((lambda *s: torch.randn(*s, dtype=torch.bfloat16) * 0.05)(D)),
        }
    _A_in = _A_setup()

    def _B_setup():
        B, S, D, F = 1, 2048, 640, 1536
        return {
            "x": _w((lambda *s: torch.randn(*s, dtype=torch.bfloat16) * 0.05)(B, S, D)),
            "w1": _w((lambda *s: torch.randn(*s, dtype=torch.bfloat16) * 0.4)(D, F) * (2.0 / D) ** 0.5),
            "w3": _w((lambda *s: torch.randn(*s, dtype=torch.bfloat16) * 0.4)(D, F) * (2.0 / D) ** 0.5),
            "w2": _w((lambda *s: torch.randn(*s, dtype=torch.bfloat16) * 0.4)(F, D) * (2.0 / F) ** 0.5),
        }
    _B_in = _B_setup()

    return {
        "A_u": _A_in["u"],
        "A_log_A_real": _A_in["log_A_real"],
        "A_A_imag": _A_in["A_imag"],
        "A_C_real": _A_in["C_real"],
        "A_C_imag": _A_in["C_imag"],
        "A_log_dt": _A_in["log_dt"],
        "A_D_skip": _A_in["D_skip"],
        "B_x": _B_in["x"],
        "B_w1": _B_in["w1"],
        "B_w3": _B_in["w3"],
        "B_w2": _B_in["w2"],
    }

def reference(A_u, A_log_A_real, A_A_imag, A_C_real, A_C_imag, A_log_dt, A_D_skip, B_x, B_w1, B_w3, B_w2):
    def _A_ref(u, log_A_real, A_imag, C_real, C_imag, log_dt, D_skip):
        L = u.shape[1]
        dt = torch.exp(log_dt)
        A = -torch.exp(log_A_real) + 1j * A_imag
        C = (C_real + 1j * C_imag) * dt[:, None]
        pos = (lambda x, dt: x.to(dt))(torch.arange(L), log_dt.dtype)
        P = torch.exp((A * dt[:, None])[:, :, None] * pos[None, None, :])
        K = 2.0 * torch.einsum("dn,dnl->dl", C, P).real
        L2 = 2 * L
        u_t = (lambda x, *d: x.permute(*d))(u, 0, 2, 1)
        Kf = (lambda x, *a, **k: torch.fft.rfft(x.float(), *a, **k))(K, L2)
        Uf = (lambda x, *a, **k: torch.fft.rfft(x.float(), *a, **k))(u_t, L2)
        y = (lambda x, *a, **k: torch.fft.irfft(x, *a, **k).to(torch.bfloat16))(Uf * Kf[None, :, :], L2)[:, :, :L]
        y = (lambda x, *d: x.permute(*d))(y, 0, 2, 1)
        return y + u * D_skip[None, None, :]

    def _B_ref(x, w1, w3, w2):
        gate = torch.einsum("bsd,df->bsf", x, w1)
        up = torch.einsum("bsd,df->bsf", x, w3)
        h = _silu(gate) * up
        out = torch.einsum("bsf,fd->bsd", h, w2)
        return out

    x = A_u
    xn = _layernorm(x, axis=-1)
    return x + _A_ref(xn, A_log_A_real, A_A_imag, A_C_real, A_C_imag, A_log_dt, A_D_skip) + _B_ref(xn, B_w1, B_w3, B_w2)
```

```asm
; @launch grid=(256,1,1) block=(512,1,1) lds=157184
.amdgcn_target "amdgcn-amd-amdhsa--gfx950"
.text
.globl parallel_sum__ssm_conv_s4d__glu_gated_swiglu__prompt_kernel
.p2align 8
.type parallel_sum__ssm_conv_s4d__glu_gated_swiglu__prompt_kernel,@function
parallel_sum__ssm_conv_s4d__glu_gated_swiglu__prompt_kernel:
    s_cmp_ge_u32 s2, 256
    s_cbranch_scc1 Lmain_end
    s_load_dwordx2 s[4:5], s[0:1], 0
    s_load_dwordx4 s[76:79], s[0:1], 64
    s_load_dwordx4 s[84:87], s[0:1], 96
    s_load_dwordx8 s[64:71], s[0:1], 8
    s_load_dwordx2 s[74:75], s[0:1], 40
    s_load_dwordx4 s[44:47], s[0:1], 80
    s_load_dwordx2 s[18:19], s[0:1], 48
    s_and_b32 s20, s2, 7
    s_lshr_b32 s21, s2, 3
    s_and_b32 s22, s20, 1
    s_lshl_b32 s22, s22, 3
    s_and_b32 s23, s21, 7
    s_add_u32 s22, s22, s23
    s_lshr_b32 s23, s20, 1
    s_lshl_b32 s23, s23, 2
    s_lshr_b32 s24, s21, 3
    s_add_u32 s23, s23, s24
    s_and_b32 s3, s20, 1
    s_lshl_b32 s3, s3, 2
    s_add_u32 s3, s3, s24
    v_lshrrev_b32 v1, 6, v0
    s_cmp_ge_u32 s22, 10
    s_cselect_b32 s35, 10, 0
    v_readfirstlane_b32 s25, v1
    s_sub_u32 s35, s22, s35
    s_nop 2
    s_and_b32 s26, s25, 1
    s_bfe_u32 s27, s25, 0x10001
    s_and_b32 s24, s25, 3
    s_cmp_ge_u32 s25, 4
    s_cbranch_scc1 Lhrole
    v_and_b32 v149, 63, v0
    v_lshrrev_b32 v150, 3, v149
    v_and_b32 v151, 7, v149
    v_lshrrev_b32 v152, 4, v149
    v_add_u32 v153, 0, v152
    v_and_b32 v153, 7, v153
    v_xor_b32 v153, v153, v151
    v_lshlrev_b32 v153, 4, v153
    v_add_u32 v154, 0, v150
    v_mul_u32_u24 v154, 1280, v154
    v_add_u32 v136, v153, v154
    v_add_u32 v153, 4, v152
    v_and_b32 v153, 7, v153
    v_xor_b32 v153, v153, v151
    v_lshlrev_b32 v153, 4, v153
    v_add_u32 v154, 8, v150
    v_mul_u32_u24 v154, 1280, v154
    v_add_u32 v137, v153, v154
    v_subrev_u32 v137, 1024, v137
    v_add_u32 v153, 8, v152
    v_and_b32 v153, 7, v153
    v_xor_b32 v153, v153, v151
    v_lshlrev_b32 v153, 4, v153
    v_add_u32 v154, 16, v150
    v_mul_u32_u24 v154, 1280, v154
    v_add_u32 v138, v153, v154
    v_subrev_u32 v138, 2048, v138
    v_add_u32 v153, 12, v152
    v_and_b32 v153, 7, v153
    v_xor_b32 v153, v153, v151
    v_lshlrev_b32 v153, 4, v153
    v_add_u32 v154, 24, v150
    v_mul_u32_u24 v154, 1280, v154
    v_add_u32 v139, v153, v154
    v_subrev_u32 v139, 3072, v139
    s_mov_b32 s28, 357913942
    v_add_u32 v153, 0, v149
    v_mul_hi_u32 v154, v153, s28
    v_mul_u32_u24 v155, 12, v154
    v_sub_u32 v155, v153, v155
    v_mul_u32_u24 v154, 3072, v154
    v_lshl_add_u32 v140, v155, 4, v154
    v_add_u32 v153, 64, v149
    v_mul_hi_u32 v154, v153, s28
    v_mul_u32_u24 v155, 12, v154
    v_sub_u32 v155, v153, v155
    v_mul_u32_u24 v154, 3072, v154
    v_lshl_add_u32 v141, v155, 4, v154
    v_subrev_u32 v141, 1024, v141
    v_add_u32 v153, 128, v149
    v_mul_hi_u32 v154, v153, s28
    v_mul_u32_u24 v155, 12, v154
    v_sub_u32 v155, v153, v155
    v_mul_u32_u24 v154, 3072, v154
    v_lshl_add_u32 v142, v155, 4, v154
    v_subrev_u32 v142, 2048, v142
    s_mul_i32 s30, s22, 163840
    s_mul_i32 s28, s25, 40960
    s_add_u32 s30, s30, s28
    s_mul_i32 s31, s23, 192
    s_mul_i32 s28, s25, 49152
    s_add_u32 s31, s31, s28
    s_lshl_b32 s28, s35, 7
    s_add_u32 s30, s30, s28
    s_mul_i32 s28, s35, 196608
    s_add_u32 s31, s31, s28
    s_mov_b32 s34, s35
    s_lshl_b32 s32, s25, 12
    s_mul_i32 s33, s25, 3072
    s_add_u32 s33, s33, 49152
    v_lshrrev_b32 v196, 5, v149
    v_and_b32 v197, 31, v149
    v_mul_u32_u24 v198, 1280, v196
    v_lshl_add_u32 v198, v197, 4, v198
    s_lshl_b32 s28, s2, 3
    s_lshl_b32 s29, s25, 1
    s_add_u32 s28, s28, s29
    s_mul_i32 s83, s28, 1280
    v_mov_b32 v168, 0
    v_mov_b32 v169, 0
    v_mov_b32 v170, 0
    v_mov_b32 v171, 0
    s_waitcnt lgkmcnt(0)
    s_mov_b32 s8, s4
    s_and_b32 s9, s5, 0xffff
    s_mov_b32 s10, 2621440
    s_mov_b32 s11, 0x20000
    s_mov_b32 s12, s76
    s_and_b32 s13, s77, 0xffff
    s_mov_b32 s14, 1966080
    s_mov_b32 s15, 0x20000
    s_mov_b32 s16, s78
    s_and_b32 s17, s79, 0xffff
    s_mov_b32 s18, 1966080
    s_mov_b32 s19, 0x20000
    s_mov_b32 s36, s86
    s_and_b32 s37, s87, 0xffff
    s_mov_b32 s38, 268435456
    s_mov_b32 s39, 0x20000
    s_mov_b32 s52, s46
    s_and_b32 s53, s47, 0xffff
    s_mov_b32 s54, 2621440
    s_mov_b32 s55, 0x20000
    buffer_load_dwordx4 v[160:163], v198, s[8:11], s83 offen
    buffer_load_dwordx4 v[164:167], v198, s[8:11], s83 offen offset:512
    s_mov_b32 exec_lo, 0xffff
    s_mov_b32 exec_hi, 0xffff
    buffer_load_dwordx4 v[168:171], v198, s[8:11], s83 offen offset:1024
    s_mov_b64 exec, -1
    s_add_u32 m0, s32, 0
    s_nop 0
    buffer_load_dwordx4 v136, s[8:11], s30 offen offset:0 lds
    buffer_load_dwordx4 v137, s[8:11], s30 offen offset:1024 lds
    buffer_load_dwordx4 v138, s[8:11], s30 offen offset:2048 lds
    buffer_load_dwordx4 v139, s[8:11], s30 offen offset:3072 lds
    s_add_u32 m0, s33, 0
    s_nop 0
    buffer_load_dwordx4 v140, s[12:15], s31 offen offset:0 lds
    buffer_load_dwordx4 v141, s[12:15], s31 offen offset:1024 lds
    buffer_load_dwordx4 v142, s[12:15], s31 offen offset:2048 lds
    s_add_u32 m0, s33, 12320
    s_nop 0
    buffer_load_dwordx4 v140, s[16:19], s31 offen offset:0 lds
    buffer_load_dwordx4 v141, s[16:19], s31 offen offset:1024 lds
    buffer_load_dwordx4 v142, s[16:19], s31 offen offset:2048 lds
    s_add_u32 s34, s34, 1
    s_cmp_eq_u32 s34, 10
    s_cselect_b32 s28, 1280, 0
    s_cselect_b32 s29, 1966080, 0
    s_cselect_b32 s34, 0, s34
    s_add_u32 s30, s30, 128
    s_add_u32 s31, s31, 196608
    s_sub_u32 s30, s30, s28
    s_sub_u32 s31, s31, s29
    v_and_b32 v150, 31, v149
    v_lshrrev_b32 v151, 5, v149
    v_bfe_u32 v152, v149, 1, 3
    v_xor_b32 v152, v152, v151
    v_lshlrev_b32 v152, 4, v152
    s_lshl_b32 s28, s27, 6
    v_add_u32 v150, s28, v150
    v_lshl_add_u32 v144, v150, 7, v152
    v_xor_b32 v145, 32, v144
    v_xor_b32 v146, 64, v144
    v_xor_b32 v147, 96, v144
    v_bfe_u32 v150, v149, 2, 2
    v_lshrrev_b32 v151, 5, v149
    v_lshl_add_u32 v150, v151, 3, v150
    v_mul_u32_u24 v150, 192, v150
    v_bfe_u32 v151, v149, 4, 1
    v_lshl_add_u32 v150, v151, 4, v150
    v_and_b32 v151, 1, v149
    v_lshl_add_u32 v150, v151, 3, v150
    v_bfe_u32 v151, v149, 1, 1
    v_mul_u32_u24 v151, 12320, v151
    v_add_u32 v150, v150, v151
    s_mul_i32 s28, s26, 96
    s_add_u32 s28, s28, 49152
    v_add_u32 v148, s28, v150
    s_add_u32 m0, s32, 16384
    s_nop 0
    buffer_load_dwordx4 v136, s[8:11], s30 offen offset:0 lds
    buffer_load_dwordx4 v137, s[8:11], s30 offen offset:1024 lds
    buffer_load_dwordx4 v138, s[8:11], s30 offen offset:2048 lds
    buffer_load_dwordx4 v139, s[8:11], s30 offen offset:3072 lds
    s_add_u32 m0, s33, 24832
    s_nop 0
    buffer_load_dwordx4 v140, s[12:15], s31 offen offset:0 lds
    buffer_load_dwordx4 v141, s[12:15], s31 offen offset:1024 lds
    buffer_load_dwordx4 v142, s[12:15], s31 offen offset:2048 lds
    s_add_u32 m0, s33, 37152
    s_nop 0
    buffer_load_dwordx4 v140, s[16:19], s31 offen offset:0 lds
    buffer_load_dwordx4 v141, s[16:19], s31 offen offset:1024 lds
    buffer_load_dwordx4 v142, s[16:19], s31 offen offset:2048 lds
    s_add_u32 s34, s34, 1
    s_cmp_eq_u32 s34, 10
    s_cselect_b32 s28, 1280, 0
    s_cselect_b32 s29, 1966080, 0
    s_cselect_b32 s34, 0, s34
    s_add_u32 s30, s30, 128
    s_add_u32 s31, s31, 196608
    s_sub_u32 s30, s30, s28
    s_sub_u32 s31, s31, s29
    s_cmp_eq_u32 s25, 0
    s_cbranch_scc0 Lnoci
    v_mov_b32 v150, 154368
    v_mov_b32 v151, 0
    ds_write_b32 v150, v151
    ds_write_b32 v150, v151 offset:4
Lnoci:
    v_mov_b32 v0, 0
    v_mov_b32 v1, 0
    v_mov_b32 v2, 0
    v_mov_b32 v3, 0
    v_mov_b32 v4, 0
    v_mov_b32 v5, 0
    v_mov_b32 v6, 0
    v_mov_b32 v7, 0
    v_mov_b32 v8, 0
    v_mov_b32 v9, 0
    v_mov_b32 v10, 0
    v_mov_b32 v11, 0
    v_mov_b32 v12, 0
    v_mov_b32 v13, 0
    v_mov_b32 v14, 0
    v_mov_b32 v15, 0
    v_mov_b32 v16, 0
    v_mov_b32 v17, 0
    v_mov_b32 v18, 0
    v_mov_b32 v19, 0
    v_mov_b32 v20, 0
    v_mov_b32 v21, 0
    v_mov_b32 v22, 0
    v_mov_b32 v23, 0
    v_mov_b32 v24, 0
    v_mov_b32 v25, 0
    v_mov_b32 v26, 0
    v_mov_b32 v27, 0
    v_mov_b32 v28, 0
    v_mov_b32 v29, 0
    v_mov_b32 v30, 0
    v_mov_b32 v31, 0
    v_mov_b32 v32, 0
    v_mov_b32 v33, 0
    v_mov_b32 v34, 0
    v_mov_b32 v35, 0
    v_mov_b32 v36, 0
    v_mov_b32 v37, 0
    v_mov_b32 v38, 0
    v_mov_b32 v39, 0
    v_mov_b32 v40, 0
    v_mov_b32 v41, 0
    v_mov_b32 v42, 0
    v_mov_b32 v43, 0
    v_mov_b32 v44, 0
    v_mov_b32 v45, 0
    v_mov_b32 v46, 0
    v_mov_b32 v47, 0
    v_mov_b32 v48, 0
    v_mov_b32 v49, 0
    v_mov_b32 v50, 0
    v_mov_b32 v51, 0
    v_mov_b32 v52, 0
    v_mov_b32 v53, 0
    v_mov_b32 v54, 0
    v_mov_b32 v55, 0
    v_mov_b32 v56, 0
    v_mov_b32 v57, 0
    v_mov_b32 v58, 0
    v_mov_b32 v59, 0
    v_mov_b32 v60, 0
    v_mov_b32 v61, 0
    v_mov_b32 v62, 0
    v_mov_b32 v63, 0
    v_mov_b32 v64, 0
    v_mov_b32 v65, 0
    v_mov_b32 v66, 0
    v_mov_b32 v67, 0
    v_mov_b32 v68, 0
    v_mov_b32 v69, 0
    v_mov_b32 v70, 0
    v_mov_b32 v71, 0
    v_mov_b32 v72, 0
    v_mov_b32 v73, 0
    v_mov_b32 v74, 0
    v_mov_b32 v75, 0
    v_mov_b32 v76, 0
    v_mov_b32 v77, 0
    v_mov_b32 v78, 0
    v_mov_b32 v79, 0
    v_mov_b32 v80, 0
    v_mov_b32 v81, 0
    v_mov_b32 v82, 0
    v_mov_b32 v83, 0
    v_mov_b32 v84, 0
    v_mov_b32 v85, 0
    v_mov_b32 v86, 0
    v_mov_b32 v87, 0
    v_mov_b32 v88, 0
    v_mov_b32 v89, 0
    v_mov_b32 v90, 0
    v_mov_b32 v91, 0
    v_mov_b32 v92, 0
    v_mov_b32 v93, 0
    v_mov_b32 v94, 0
    v_mov_b32 v95, 0
    s_waitcnt vmcnt(20)
    v_lshlrev_b32 v172, 16, v160
    v_and_b32 v173, 0xffff0000, v160
    v_lshlrev_b32 v174, 16, v161
    v_and_b32 v175, 0xffff0000, v161
    v_lshlrev_b32 v176, 16, v162
    v_and_b32 v177, 0xffff0000, v162
    v_lshlrev_b32 v178, 16, v163
    v_and_b32 v179, 0xffff0000, v163
    v_lshlrev_b32 v180, 16, v164
    v_and_b32 v181, 0xffff0000, v164
    v_lshlrev_b32 v182, 16, v165
    v_and_b32 v183, 0xffff0000, v165
    v_lshlrev_b32 v184, 16, v166
    v_and_b32 v185, 0xffff0000, v166
    v_lshlrev_b32 v186, 16, v167
    v_and_b32 v187, 0xffff0000, v167
    v_lshlrev_b32 v188, 16, v168
    v_and_b32 v189, 0xffff0000, v168
    v_lshlrev_b32 v190, 16, v169
    v_and_b32 v191, 0xffff0000, v169
    v_lshlrev_b32 v192, 16, v170
    v_and_b32 v193, 0xffff0000, v170
    v_lshlrev_b32 v194, 16, v171
    v_and_b32 v195, 0xffff0000, v171
    v_pk_add_f32 v[200:201], v[172:173], v[174:175]
    v_pk_mul_f32 v[202:203], v[172:173], v[172:173]
    v_pk_fma_f32 v[202:203], v[174:175], v[174:175], v[202:203]
    v_pk_add_f32 v[200:201], v[200:201], v[176:177]
    v_pk_fma_f32 v[202:203], v[176:177], v[176:177], v[202:203]
    v_pk_add_f32 v[200:201], v[200:201], v[178:179]
    v_pk_fma_f32 v[202:203], v[178:179], v[178:179], v[202:203]
    v_pk_add_f32 v[200:201], v[200:201], v[180:181]
    v_pk_fma_f32 v[202:203], v[180:181], v[180:181], v[202:203]
    v_pk_add_f32 v[200:201], v[200:201], v[182:183]
    v_pk_fma_f32 v[202:203], v[182:183], v[182:183], v[202:203]
    v_pk_add_f32 v[200:201], v[200:201], v[184:185]
    v_pk_fma_f32 v[202:203], v[184:185], v[184:185], v[202:203]
    v_pk_add_f32 v[200:201], v[200:201], v[186:187]
    v_pk_fma_f32 v[202:203], v[186:187], v[186:187], v[202:203]
    v_pk_add_f32 v[200:201], v[200:201], v[188:189]
    v_pk_fma_f32 v[202:203], v[188:189], v[188:189], v[202:203]
    v_pk_add_f32 v[200:201], v[200:201], v[190:191]
    v_pk_fma_f32 v[202:203], v[190:191], v[190:191], v[202:203]
    v_pk_add_f32 v[200:201], v[200:201], v[192:193]
    v_pk_fma_f32 v[202:203], v[192:193], v[192:193], v[202:203]
    v_pk_add_f32 v[200:201], v[200:201], v[194:195]
    v_pk_fma_f32 v[202:203], v[194:195], v[194:195], v[202:203]
    s_nop 0
    v_add_f32 v200, v200, v201
    v_add_f32 v202, v202, v203
    s_nop 1
    v_add_f32_dpp v200, v200, v200 quad_perm:[1,0,3,2] row_mask:0xf bank_mask:0xf
    v_add_f32_dpp v202, v202, v202 quad_perm:[1,0,3,2] row_mask:0xf bank_mask:0xf
    s_nop 1
    v_add_f32_dpp v200, v200, v200 quad_perm:[2,3,0,1] row_mask:0xf bank_mask:0xf
    v_add_f32_dpp v202, v202, v202 quad_perm:[2,3,0,1] row_mask:0xf bank_mask:0xf
    s_nop 1
    v_add_f32_dpp v200, v200, v200 row_half_mirror row_mask:0xf bank_mask:0xf
    v_add_f32_dpp v202, v202, v202 row_half_mirror row_mask:0xf bank_mask:0xf
    s_nop 1
    v_add_f32_dpp v200, v200, v200 row_mirror row_mask:0xf bank_mask:0xf
    v_add_f32_dpp v202, v202, v202 row_mirror row_mask:0xf bank_mask:0xf
    v_mov_b32 v204, v200
    v_mov_b32 v205, v202
    s_nop 1
    v_permlane16_swap_b32 v204, v200
    v_permlane16_swap_b32 v205, v202
    s_nop 1
    v_add_f32 v200, v200, v204
    v_add_f32 v202, v202, v205
    v_mul_f32 v200, 0x3acccccd, v200
    v_mul_f32 v202, 0x3acccccd, v202
    v_fma_f32 v202, -v200, v200, v202
    v_max_f32 v202, 0, v202
    v_cvt_pk_bf16_f32 v202, v202, v202
    v_cvt_pk_bf16_f32 v200, v200, v200
    v_lshlrev_b32 v202, 16, v202
    v_lshlrev_b32 v200, 16, v200
    v_add_f32 v202, 0x3727c5ac, v202
    v_cvt_pk_bf16_f32 v202, v202, v202
    v_lshlrev_b32 v202, 16, v202
    v_sqrt_f32 v202, v202
    s_nop 0
    v_cvt_pk_bf16_f32 v202, v202, v202
    v_lshlrev_b32 v202, 16, v202
    v_rcp_f32 v202, v202
    s_nop 0
    v_mov_b32 v201, v202
    v_mul_f32 v208, v200, v202
    v_mov_b32 v210, v202
    v_sub_f32 v208, 0, v208
    v_lshrrev_b32 v204, 5, v149
    s_lshl_b32 s29, s25, 1
    v_add_u32 v204, s29, v204
    v_lshlrev_b32 v205, 3, v204
    v_add_u32 v205, 154432, v205
    v_mul_u32_u24 v204, 1344, v204
    v_and_b32 v206, 31, v149
    v_lshl_add_u32 v204, v206, 4, v204
    v_add_u32 v204, 143360, v204
    v_pk_fma_f32 v[172:173], v[172:173], v[210:211], v[208:209] op_sel_hi:[1,0,0]
    v_pk_fma_f32 v[174:175], v[174:175], v[210:211], v[208:209] op_sel_hi:[1,0,0]
    v_pk_fma_f32 v[176:177], v[176:177], v[210:211], v[208:209] op_sel_hi:[1,0,0]
    v_pk_fma_f32 v[178:179], v[178:179], v[210:211], v[208:209] op_sel_hi:[1,0,0]
    v_pk_fma_f32 v[180:181], v[180:181], v[210:211], v[208:209] op_sel_hi:[1,0,0]
    v_pk_fma_f32 v[182:183], v[182:183], v[210:211], v[208:209] op_sel_hi:[1,0,0]
    v_pk_fma_f32 v[184:185], v[184:185], v[210:211], v[208:209] op_sel_hi:[1,0,0]
    v_pk_fma_f32 v[186:187], v[186:187], v[210:211], v[208:209] op_sel_hi:[1,0,0]
    v_pk_fma_f32 v[188:189], v[188:189], v[210:211], v[208:209] op_sel_hi:[1,0,0]
    v_pk_fma_f32 v[190:191], v[190:191], v[210:211], v[208:209] op_sel_hi:[1,0,0]
    v_pk_fma_f32 v[192:193], v[192:193], v[210:211], v[208:209] op_sel_hi:[1,0,0]
    v_pk_fma_f32 v[194:195], v[194:195], v[210:211], v[208:209] op_sel_hi:[1,0,0]
    v_cvt_pk_bf16_f32 v160, v172, v173
    v_cvt_pk_bf16_f32 v161, v174, v175
    v_cvt_pk_bf16_f32 v162, v176, v177
    v_cvt_pk_bf16_f32 v163, v178, v179
    v_cvt_pk_bf16_f32 v164, v180, v181
    v_cvt_pk_bf16_f32 v165, v182, v183
    v_cvt_pk_bf16_f32 v166, v184, v185
    v_cvt_pk_bf16_f32 v167, v186, v187
    v_cvt_pk_bf16_f32 v168, v188, v189
    v_cvt_pk_bf16_f32 v169, v190, v191
    v_cvt_pk_bf16_f32 v170, v192, v193
    v_cvt_pk_bf16_f32 v171, v194, v195
    ds_write_b128 v204, v[160:163]
    ds_write_b128 v204, v[164:167] offset:512
    s_mov_b32 exec_lo, 0xffff
    s_mov_b32 exec_hi, 0xffff
    ds_write_b128 v204, v[168:171] offset:1024
    s_mov_b32 exec_lo, 1
    s_mov_b32 exec_hi, 1
    ds_write_b64 v205, v[200:201]
    s_mov_b64 exec, -1
    s_waitcnt vmcnt(10) lgkmcnt(0)
    s_barrier
    ds_read_b128 v[120:123], v144 offset:0
    ds_read_b64_tr_b16 v[96:97], v148 offset:0
    ds_read_b64_tr_b16 v[98:99], v148 offset:768
    ds_read_b128 v[124:127], v144 offset:4096
    ds_read_b64_tr_b16 v[100:101], v148 offset:32
    ds_read_b64_tr_b16 v[102:103], v148 offset:800
    ds_read_b64_tr_b16 v[104:105], v148 offset:64
    ds_read_b64_tr_b16 v[106:107], v148 offset:832
    s_add_u32 m0, s32, 32768
    s_nop 0
    buffer_load_dwordx4 v136, s[8:11], s30 offen offset:0 lds
    buffer_load_dwordx4 v137, s[8:11], s30 offen offset:1024 lds
    s_waitcnt lgkmcnt(0)
    v_mfma_f32_32x32x16_bf16 v[0:15], v[96:99], v[120:123], v[0:15]
    ds_read_b128 v[128:131], v145 offset:0
    ds_read_b64_tr_b16 v[108:109], v148 offset:3072
    ds_read_b64_tr_b16 v[110:111], v148 offset:3840
    v_mfma_f32_32x32x16_bf16 v[16:31], v[96:99], v[124:127], v[16:31]
    ds_read_b128 v[132:135], v145 offset:4096
    ds_read_b64_tr_b16 v[112:113], v148 offset:3104
    ds_read_b64_tr_b16 v[114:115], v148 offset:3872
    v_mfma_f32_32x32x16_bf16 v[32:47], v[100:103], v[120:123], v[32:47]
    ds_read_b64_tr_b16 v[116:117], v148 offset:3136
    ds_read_b64_tr_b16 v[118:119], v148 offset:3904
    v_mfma_f32_32x32x16_bf16 v[48:63], v[100:103], v[124:127], v[48:63]
    buffer_load_dwordx4 v138, s[8:11], s30 offen offset:2048 lds
    v_mfma_f32_32x32x16_bf16 v[64:79], v[104:107], v[120:123], v[64:79]
    buffer_load_dwordx4 v139, s[8:11], s30 offen offset:3072 lds
    v_mfma_f32_32x32x16_bf16 v[80:95], v[104:107], v[124:127], v[80:95]
    s_add_u32 m0, s33, 49664
    s_nop 0
    buffer_load_dwordx4 v140, s[12:15], s31 offen offset:0 lds
    s_waitcnt lgkmcnt(0)
    v_mfma_f32_32x32x16_bf16 v[0:15], v[108:111], v[128:131], v[0:15]
    ds_read_b128 v[120:123], v146 offset:0
    ds_read_b64_tr_b16 v[96:97], v148 offset:6144
    ds_read_b64_tr_b16 v[98:99], v148 offset:6912
    v_mfma_f32_32x32x16_bf16 v[16:31], v[108:111], v[132:135], v[16:31]
    ds_read_b128 v[124:127], v146 offset:4096
    ds_read_b64_tr_b16 v[100:101], v148 offset:6176
    ds_read_b64_tr_b16 v[102:103], v148 offset:6944
    v_mfma_f32_32x32x16_bf16 v[32:47], v[112:115], v[128:131], v[32:47]
    ds_read_b64_tr_b16 v[104:105], v148 offset:6208
    ds_read_b64_tr_b16 v[106:107], v148 offset:6976
    v_mfma_f32_32x32x16_bf16 v[48:63], v[112:115], v[132:135], v[48:63]
    buffer_load_dwordx4 v141, s[12:15], s31 offen offset:1024 lds
    v_mfma_f32_32x32x16_bf16 v[64:79], v[116:119], v[128:131], v[64:79]
    buffer_load_dwordx4 v142, s[12:15], s31 offen offset:2048 lds
    v_mfma_f32_32x32x16_bf16 v[80:95], v[116:119], v[132:135], v[80:95]
    s_waitcnt lgkmcnt(0)
    v_mfma_f32_32x32x16_bf16 v[0:15], v[96:99], v[120:123], v[0:15]
    ds_read_b128 v[128:131], v147 offset:0
    ds_read_b64_tr_b16 v[108:109], v148 offset:9216
    ds_read_b64_tr_b16 v[110:111], v148 offset:9984
    v_mfma_f32_32x32x16_bf16 v[16:31], v[96:99], v[124:127], v[16:31]
    ds_read_b128 v[132:135], v147 offset:4096
    ds_read_b64_tr_b16 v[112:113], v148 offset:9248
    ds_read_b64_tr_b16 v[114:115], v148 offset:10016
    v_mfma_f32_32x32x16_bf16 v[32:47], v[100:103], v[120:123], v[32:47]
    ds_read_b64_tr_b16 v[116:117], v148 offset:9280
    ds_read_b64_tr_b16 v[118:119], v148 offset:10048
    v_mfma_f32_32x32x16_bf16 v[48:63], v[100:103], v[124:127], v[48:63]
    s_add_u32 m0, s33, 61984
    s_nop 0
    buffer_load_dwordx4 v140, s[16:19], s31 offen offset:0 lds
    v_mfma_f32_32x32x16_bf16 v[64:79], v[104:107], v[120:123], v[64:79]
    buffer_load_dwordx4 v141, s[16:19], s31 offen offset:1024 lds
    v_mfma_f32_32x32x16_bf16 v[80:95], v[104:107], v[124:127], v[80:95]
    buffer_load_dwordx4 v142, s[16:19], s31 offen offset:2048 lds
    s_add_u32 s34, s34, 1
    s_cmp_eq_u32 s34, 10
    s_cselect_b32 s28, 1280, 0
    s_cselect_b32 s29, 1966080, 0
    s_cselect_b32 s34, 0, s34
    s_add_u32 s30, s30, 128
    s_add_u32 s31, s31, 196608
    s_sub_u32 s30, s30, s28
    s_sub_u32 s31, s31, s29
    s_waitcnt vmcnt(10) lgkmcnt(0)
    s_barrier
    v_mfma_f32_32x32x16_bf16 v[0:15], v[108:111], v[128:131], v[0:15]
    ds_read_b128 v[120:123], v144 offset:16384
    ds_read_b64_tr_b16 v[96:97], v148 offset:24832
    ds_read_b64_tr_b16 v[98:99], v148 offset:25600
    v_mfma_f32_32x32x16_bf16 v[16:31], v[108:111], v[132:135], v[16:31]
    ds_read_b128 v[124:127], v144 offset:20480
    ds_read_b64_tr_b16 v[100:101], v148 offset:24864
    ds_read_b64_tr_b16 v[102:103], v148 offset:25632
    v_mfma_f32_32x32x16_bf16 v[32:47], v[112:115], v[128:131], v[32:47]
    ds_read_b64_tr_b16 v[104:105], v148 offset:24896
    ds_read_b64_tr_b16 v[106:107], v148 offset:25664
    v_mfma_f32_32x32x16_bf16 v[48:63], v[112:115], v[132:135], v[48:63]
    s_add_u32 m0, s32, 0
    s_nop 0
    buffer_load_dwordx4 v136, s[8:11], s30 offen offset:0 lds
    v_mfma_f32_32x32x16_bf16 v[64:79], v[116:119], v[128:131], v[64:79]
    buffer_load_dwordx4 v137, s[8:11], s30 offen offset:1024 lds
    v_mfma_f32_32x32x16_bf16 v[80:95], v[116:119], v[132:135], v[80:95]
    s_waitcnt lgkmcnt(0)
    v_mfma_f32_32x32x16_bf16 v[0:15], v[96:99], v[120:123], v[0:15]
    ds_read_b128 v[128:131], v145 offset:16384
    ds_read_b64_tr_b16 v[108:109], v148 offset:27904
    ds_read_b64_tr_b16 v[110:111], v148 offset:28672
    v_mfma_f32_32x32x16_bf16 v[16:31], v[96:99], v[124:127], v[16:31]
    ds_read_b128 v[132:135], v145 offset:20480
    ds_read_b64_tr_b16 v[112:113], v148 offset:27936
    ds_read_b64_tr_b16 v[114:115], v148 offset:28704
    v_mfma_f32_32x32x16_bf16 v[32:47], v[100:103], v[120:123], v[32:47]
    ds_read_b64_tr_b16 v[116:117], v148 offset:27968
    ds_read_b64_tr_b16 v[118:119], v148 offset:28736
    v_mfma_f32_32x32x16_bf16 v[48:63], v[100:103], v[124:127], v[48:63]
    buffer_load_dwordx4 v138, s[8:11], s30 offen offset:2048 lds
    v_mfma_f32_32x32x16_bf16 v[64:79], v[104:107], v[120:123], v[64:79]
    buffer_load_dwordx4 v139, s[8:11], s30 offen offset:3072 lds
    v_mfma_f32_32x32x16_bf16 v[80:95], v[104:107], v[124:127], v[80:95]
    s_add_u32 m0, s33, 0
    s_nop 0
    buffer_load_dwordx4 v140, s[12:15], s31 offen offset:0 lds
    s_waitcnt lgkmcnt(0)
    v_mfma_f32_32x32x16_bf16 v[0:15], v[108:111], v[128:131], v[0:15]
    ds_read_b128 v[120:123], v146 offset:16384
    ds_read_b64_tr_b16 v[96:97], v148 offset:30976
    ds_read_b64_tr_b16 v[98:99], v148 offset:31744
    v_mfma_f32_32x32x16_bf16 v[16:31], v[108:111], v[132:135], v[16:31]
    ds_read_b128 v[124:127], v146 offset:20480
    ds_read_b64_tr_b16 v[100:101], v148 offset:31008
    ds_read_b64_tr_b16 v[102:103], v148 offset:31776
    v_mfma_f32_32x32x16_bf16 v[32:47], v[112:115], v[128:131], v[32:47]
    ds_read_b64_tr_b16 v[104:105], v148 offset:31040
    ds_read_b64_tr_b16 v[106:107], v148 offset:31808
    v_mfma_f32_32x32x16_bf16 v[48:63], v[112:115], v[132:135], v[48:63]
    buffer_load_dwordx4 v141, s[12:15], s31 offen offset:1024 lds
    v_mfma_f32_32x32x16_bf16 v[64:79], v[116:119], v[128:131], v[64:79]
    buffer_load_dwordx4 v142, s[12:15], s31 offen offset:2048 lds
    v_mfma_f32_32x32x16_bf16 v[80:95], v[116:119], v[132:135], v[80:95]
    s_waitcnt lgkmcnt(0)
    v_mfma_f32_32x32x16_bf16 v[0:15], v[96:99], v[120:123], v[0:15]
    ds_read_b128 v[128:131], v147 offset:16384
    ds_read_b64_tr_b16 v[108:109], v148 offset:34048
    ds_read_b64_tr_b16 v[110:111], v148 offset:34816
    v_mfma_f32_32x32x16_bf16 v[16:31], v[96:99], v[124:127], v[16:31]
    ds_read_b128 v[132:135], v147 offset:20480
    ds_read_b64_tr_b16 v[112:113], v148 offset:34080
    ds_read_b64_tr_b16 v[114:115], v148 offset:34848
    v_mfma_f32_32x32x16_bf16 v[32:47], v[100:103], v[120:123], v[32:47]
    ds_read_b64_tr_b16 v[116:117], v148 offset:34112
    ds_read_b64_tr_b16 v[118:119], v148 offset:34880
    v_mfma_f32_32x32x16_bf16 v[48:63], v[100:103], v[124:127], v[48:63]
    s_add_u32 m0, s33, 12320
    s_nop 0
    buffer_load_dwordx4 v140, s[16:19], s31 offen offset:0 lds
    v_mfma_f32_32x32x16_bf16 v[64:79], v[104:107], v[120:123], v[64:79]
    buffer_load_dwordx4 v141, s[16:19], s31 offen offset:1024 lds
    v_mfma_f32_32x32x16_bf16 v[80:95], v[104:107], v[124:127], v[80:95]
    buffer_load_dwordx4 v142, s[16:19], s31 offen offset:2048 lds
    s_add_u32 s34, s34, 1
    s_cmp_eq_u32 s34, 10
    s_cselect_b32 s28, 1280, 0
    s_cselect_b32 s29, 1966080, 0
    s_cselect_b32 s34, 0, s34
    s_add_u32 s30, s30, 128
    s_add_u32 s31, s31, 196608
    s_sub_u32 s30, s30, s28
    s_sub_u32 s31, s31, s29
    s_waitcnt vmcnt(10) lgkmcnt(0)
    s_barrier
    v_mfma_f32_32x32x16_bf16 v[0:15], v[108:111], v[128:131], v[0:15]
    ds_read_b128 v[120:123], v144 offset:32768
    ds_read_b64_tr_b16 v[96:97], v148 offset:49664
    ds_read_b64_tr_b16 v[98:99], v148 offset:50432
    v_mfma_f32_32x32x16_bf16 v[16:31], v[108:111], v[132:135], v[16:31]
    ds_read_b128 v[124:127], v144 offset:36864
    ds_read_b64_tr_b16 v[100:101], v148 offset:49696
    ds_read_b64_tr_b16 v[102:103], v148 offset:50464
    v_mfma_f32_32x32x16_bf16 v[32:47], v[112:115], v[128:131], v[32:47]
    ds_read_b64_tr_b16 v[104:105], v148 offset:49728
    ds_read_b64_tr_b16 v[106:107], v148 offset:50496
    v_mfma_f32_32x32x16_bf16 v[48:63], v[112:115], v[132:135], v[48:63]
    s_add_u32 m0, s32, 16384
    s_nop 0
    buffer_load_dwordx4 v136, s[8:11], s30 offen offset:0 lds
    v_mfma_f32_32x32x16_bf16 v[64:79], v[116:119], v[128:131], v[64:79]
    buffer_load_dwordx4 v137, s[8:11], s30 offen offset:1024 lds
    v_mfma_f32_32x32x16_bf16 v[80:95], v[116:119], v[132:135], v[80:95]
    s_waitcnt lgkmcnt(0)
    v_mfma_f32_32x32x16_bf16 v[0:15], v[96:99], v[120:123], v[0:15]
    ds_read_b128 v[128:131], v145 offset:32768
    ds_read_b64_tr_b16 v[108:109], v148 offset:52736
    ds_read_b64_tr_b16 v[110:111], v148 offset:53504
    v_mfma_f32_32x32x16_bf16 v[16:31], v[96:99], v[124:127], v[16:31]
    ds_read_b128 v[132:135], v145 offset:36864
    ds_read_b64_tr_b16 v[112:113], v148 offset:52768
    ds_read_b64_tr_b16 v[114:115], v148 offset:53536
    v_mfma_f32_32x32x16_bf16 v[32:47], v[100:103], v[120:123], v[32:47]
    ds_read_b64_tr_b16 v[116:117], v148 offset:52800
    ds_read_b64_tr_b16 v[118:119], v148 offset:53568
    v_mfma_f32_32x32x16_bf16 v[48:63], v[100:103], v[124:127], v[48:63]
    buffer_load_dwordx4 v138, s[8:11], s30 offen offset:2048 lds
    v_mfma_f32_32x32x16_bf16 v[64:79], v[104:107], v[120:123], v[64:79]
    buffer_load_dwordx4 v139, s[8:11], s30 offen offset:3072 lds
    v_mfma_f32_32x32x16_bf16 v[80:95], v[104:107], v[124:127], v[80:95]
    s_add_u32 m0, s33, 24832
    s_nop 0
    buffer_load_dwordx4 v140, s[12:15], s31 offen offset:0 lds
    s_waitcnt lgkmcnt(0)
    v_mfma_f32_32x32x16_bf16 v[0:15], v[108:111], v[128:131], v[0:15]
    ds_read_b128 v[120:123], v146 offset:32768
    ds_read_b64_tr_b16 v[96:97], v148 offset:55808
    ds_read_b64_tr_b16 v[98:99], v148 offset:56576
    v_mfma_f32_32x32x16_bf16 v[16:31], v[108:111], v[132:135], v[16:31]
    ds_read_b128 v[124:127], v146 offset:36864
    ds_read_b64_tr_b16 v[100:101], v148 offset:55840
    ds_read_b64_tr_b16 v[102:103], v148 offset:56608
    v_mfma_f32_32x32x16_bf16 v[32:47], v[112:115], v[128:131], v[32:47]
    ds_read_b64_tr_b16 v[104:105], v148 offset:55872
    ds_read_b64_tr_b16 v[106:107], v148 offset:56640
    v_mfma_f32_32x32x16_bf16 v[48:63], v[112:115], v[132:135], v[48:63]
    buffer_load_dwordx4 v141, s[12:15], s31 offen offset:1024 lds
    v_mfma_f32_32x32x16_bf16 v[64:79], v[116:119], v[128:131], v[64:79]
    buffer_load_dwordx4 v142, s[12:15], s31 offen offset:2048 lds
    v_mfma_f32_32x32x16_bf16 v[80:95], v[116:119], v[132:135], v[80:95]
    s_waitcnt lgkmcnt(0)
    v_mfma_f32_32x32x16_bf16 v[0:15], v[96:99], v[120:123], v[0:15]
    ds_read_b128 v[128:131], v147 offset:32768
    ds_read_b64_tr_b16 v[108:109], v148 offset:58880
    ds_read_b64_tr_b16 v[110:111], v148 offset:59648
    v_mfma_f32_32x32x16_bf16 v[16:31], v[96:99], v[124:127], v[16:31]
    ds_read_b128 v[132:135], v147 offset:36864
    ds_read_b64_tr_b16 v[112:113], v148 offset:58912
    ds_read_b64_tr_b16 v[114:115], v148 offset:59680
    v_mfma_f32_32x32x16_bf16 v[32:47], v[100:103], v[120:123], v[32:47]
    ds_read_b64_tr_b16 v[116:117], v148 offset:58944
    ds_read_b64_tr_b16 v[118:119], v148 offset:59712
    v_mfma_f32_32x32x16_bf16 v[48:63], v[100:103], v[124:127], v[48:63]
    s_add_u32 m0, s33, 37152
    s_nop 0
    buffer_load_dwordx4 v140, s[16:19], s31 offen offset:0 lds
    v_mfma_f32_32x32x16_bf16 v[64:79], v[104:107], v[120:123], v[64:79]
    buffer_load_dwordx4 v141, s[16:19], s31 offen offset:1024 lds
    v_mfma_f32_32x32x16_bf16 v[80:95], v[104:107], v[124:127], v[80:95]
    buffer_load_dwordx4 v142, s[16:19], s31 offen offset:2048 lds
    s_add_u32 s34, s34, 1
    s_cmp_eq_u32 s34, 10
    s_cselect_b32 s28, 1280, 0
    s_cselect_b32 s29, 1966080, 0
    s_cselect_b32 s34, 0, s34
    s_add_u32 s30, s30, 128
    s_add_u32 s31, s31, 196608
    s_sub_u32 s30, s30, s28
    s_sub_u32 s31, s31, s29
    s_waitcnt vmcnt(10) lgkmcnt(0)
    s_barrier
    v_mfma_f32_32x32x16_bf16 v[0:15], v[108:111], v[128:131], v[0:15]
    ds_read_b128 v[120:123], v144 offset:0
    ds_read_b64_tr_b16 v[96:97], v148 offset:0
    ds_read_b64_tr_b16 v[98:99], v148 offset:768
    v_mfma_f32_32x32x16_bf16 v[16:31], v[108:111], v[132:135], v[16:31]
    ds_read_b128 v[124:127], v144 offset:4096
    ds_read_b64_tr_b16 v[100:101], v148 offset:32
    ds_read_b64_tr_b16 v[102:103], v148 offset:800
    v_mfma_f32_32x32x16_bf16 v[32:47], v[112:115], v[128:131], v[32:47]
    ds_read_b64_tr_b16 v[104:105], v148 offset:64
    ds_read_b64_tr_b16 v[106:107], v148 offset:832
    v_mfma_f32_32x32x16_bf16 v[48:63], v[112:115], v[132:135], v[48:63]
    s_add_u32 m0, s32, 32768
    s_nop 0
    buffer_load_dwordx4 v136, s[8:11], s30 offen offset:0 lds
    v_mfma_f32_32x32x16_bf16 v[64:79], v[116:119], v[128:131], v[64:79]
    buffer_load_dwordx4 v137, s[8:11], s30 offen offset:1024 lds
    v_mfma_f32_32x32x16_bf16 v[80:95], v[116:119], v[132:135], v[80:95]
    s_waitcnt lgkmcnt(0)
    v_mfma_f32_32x32x16_bf16 v[0:15], v[96:99], v[120:123], v[0:15]
    ds_read_b128 v[128:131], v145 offset:0
    ds_read_b64_tr_b16 v[108:109], v148 offset:3072
    ds_read_b64_tr_b16 v[110:111], v148 offset:3840
    v_mfma_f32_32x32x16_bf16 v[16:31], v[96:99], v[124:127], v[16:31]
    ds_read_b128 v[132:135], v145 offset:4096
    ds_read_b64_tr_b16 v[112:113], v148 offset:3104
    ds_read_b64_tr_b16 v[114:115], v148 offset:3872
    v_mfma_f32_32x32x16_bf16 v[32:47], v[100:103], v[120:123], v[32:47]
    ds_read_b64_tr_b16 v[116:117], v148 offset:3136
    ds_read_b64_tr_b16 v[118:119], v148 offset:3904
    v_mfma_f32_32x32x16_bf16 v[48:63], v[100:103], v[124:127], v[48:63]
    buffer_load_dwordx4 v138, s[8:11], s30 offen offset:2048 lds
    v_mfma_f32_32x32x16_bf16 v[64:79], v[104:107], v[120:123], v[64:79]
    buffer_load_dwordx4 v139, s[8:11], s30 offen offset:3072 lds
    v_mfma_f32_32x32x16_bf16 v[80:95], v[104:107], v[124:127], v[80:95]
    s_add_u32 m0, s33, 49664
    s_nop 0
    buffer_load_dwordx4 v140, s[12:15], s31 offen offset:0 lds
    s_waitcnt lgkmcnt(0)
    v_mfma_f32_32x32x16_bf16 v[0:15], v[108:111], v[128:131], v[0:15]
    ds_read_b128 v[120:123], v146 offset:0
    ds_read_b64_tr_b16 v[96:97], v148 offset:6144
    ds_read_b64_tr_b16 v[98:99], v148 offset:6912
    v_mfma_f32_32x32x16_bf16 v[16:31], v[108:111], v[132:135], v[16:31]
    ds_read_b128 v[124:127], v146 offset:4096
    ds_read_b64_tr_b16 v[100:101], v148 offset:6176
    ds_read_b64_tr_b16 v[102:103], v148 offset:6944
    v_mfma_f32_32x32x16_bf16 v[32:47], v[112:115], v[128:131], v[32:47]
    ds_read_b64_tr_b16 v[104:105], v148 offset:6208
    ds_read_b64_tr_b16 v[106:107], v148 offset:6976
    v_mfma_f32_32x32x16_bf16 v[48:63], v[112:115], v[132:135], v[48:63]
    buffer_load_dwordx4 v141, s[12:15], s31 offen offset:1024 lds
    v_mfma_f32_32x32x16_bf16 v[64:79], v[116:119], v[128:131], v[64:79]
    buffer_load_dwordx4 v142, s[12:15], s31 offen offset:2048 lds
    v_mfma_f32_32x32x16_bf16 v[80:95], v[116:119], v[132:135], v[80:95]
    s_waitcnt lgkmcnt(0)
    v_mfma_f32_32x32x16_bf16 v[0:15], v[96:99], v[120:123], v[0:15]
    ds_read_b128 v[128:131], v147 offset:0
    ds_read_b64_tr_b16 v[108:109], v148 offset:9216
    ds_read_b64_tr_b16 v[110:111], v148 offset:9984
    v_mfma_f32_32x32x16_bf16 v[16:31], v[96:99], v[124:127], v[16:31]
    ds_read_b128 v[132:135], v147 offset:4096
    ds_read_b64_tr_b16 v[112:113], v148 offset:9248
    ds_read_b64_tr_b16 v[114:115], v148 offset:10016
    v_mfma_f32_32x32x16_bf16 v[32:47], v[100:103], v[120:123], v[32:47]
    ds_read_b64_tr_b16 v[116:117], v148 offset:9280
    ds_read_b64_tr_b16 v[118:119], v148 offset:10048
    v_mfma_f32_32x32x16_bf16 v[48:63], v[100:103], v[124:127], v[48:63]
    s_add_u32 m0, s33, 61984
    s_nop 0
    buffer_load_dwordx4 v140, s[16:19], s31 offen offset:0 lds
    v_mfma_f32_32x32x16_bf16 v[64:79], v[104:107], v[120:123], v[64:79]
    buffer_load_dwordx4 v141, s[16:19], s31 offen offset:1024 lds
    v_mfma_f32_32x32x16_bf16 v[80:95], v[104:107], v[124:127], v[80:95]
    buffer_load_dwordx4 v142, s[16:19], s31 offen offset:2048 lds
    s_add_u32 s34, s34, 1
    s_cmp_eq_u32 s34, 10
    s_cselect_b32 s28, 1280, 0
    s_cselect_b32 s29, 1966080, 0
    s_cselect_b32 s34, 0, s34
    s_add_u32 s30, s30, 128
    s_add_u32 s31, s31, 196608
    s_sub_u32 s30, s30, s28
    s_sub_u32 s31, s31, s29
    s_waitcnt vmcnt(10) lgkmcnt(0)
    s_barrier
    v_mfma_f32_32x32x16_bf16 v[0:15], v[108:111], v[128:131], v[0:15]
    ds_read_b128 v[120:123], v144 offset:16384
    ds_read_b64_tr_b16 v[96:97], v148 offset:24832
    ds_read_b64_tr_b16 v[98:99], v148 offset:25600
    v_mfma_f32_32x32x16_bf16 v[16:31], v[108:111], v[132:135], v[16:31]
    ds_read_b128 v[124:127], v144 offset:20480
    ds_read_b64_tr_b16 v[100:101], v148 offset:24864
    ds_read_b64_tr_b16 v[102:103], v148 offset:25632
    v_mfma_f32_32x32x16_bf16 v[32:47], v[112:115], v[128:131], v[32:47]
    ds_read_b64_tr_b16 v[104:105], v148 offset:24896
    ds_read_b64_tr_b16 v[106:107], v148 offset:25664
    v_mfma_f32_32x32x16_bf16 v[48:63], v[112:115], v[132:135], v[48:63]
    s_add_u32 m0, s32, 0
    s_nop 0
    buffer_load_dwordx4 v136, s[8:11], s30 offen offset:0 lds
    v_mfma_f32_32x32x16_bf16 v[64:79], v[116:119], v[128:131], v[64:79]
    buffer_load_dwordx4 v137, s[8:11], s30 offen offset:1024 lds
    v_mfma_f32_32x32x16_bf16 v[80:95], v[116:119], v[132:135], v[80:95]
    s_waitcnt lgkmcnt(0)
    v_mfma_f32_32x32x16_bf16 v[0:15], v[96:99], v[120:123], v[0:15]
    ds_read_b128 v[128:131], v145 offset:16384
    ds_read_b64_tr_b16 v[108:109], v148 offset:27904
    ds_read_b64_tr_b16 v[110:111], v148 offset:28672
    v_mfma_f32_32x32x16_bf16 v[16:31], v[96:99], v[124:127], v[16:31]
    ds_read_b128 v[132:135], v145 offset:20480
    ds_read_b64_tr_b16 v[112:113], v148 offset:27936
    ds_read_b64_tr_b16 v[114:115], v148 offset:28704
    v_mfma_f32_32x32x16_bf16 v[32:47], v[100:103], v[120:123], v[32:47]
    ds_read_b64_tr_b16 v[116:117], v148 offset:27968
    ds_read_b64_tr_b16 v[118:119], v148 offset:28736
    v_mfma_f32_32x32x16_bf16 v[48:63], v[100:103], v[124:127], v[48:63]
    buffer_load_dwordx4 v138, s[8:11], s30 offen offset:2048 lds
    v_mfma_f32_32x32x16_bf16 v[64:79], v[104:107], v[120:123], v[64:79]
    buffer_load_dwordx4 v139, s[8:11], s30 offen offset:3072 lds
    v_mfma_f32_32x32x16_bf16 v[80:95], v[104:107], v[124:127], v[80:95]
    s_add_u32 m0, s33, 0
    s_nop 0
    buffer_load_dwordx4 v140, s[12:15], s31 offen offset:0 lds
    s_waitcnt lgkmcnt(0)
    v_mfma_f32_32x32x16_bf16 v[0:15], v[108:111], v[128:131], v[0:15]
    ds_read_b128 v[120:123], v146 offset:16384
    ds_read_b64_tr_b16 v[96:97], v148 offset:30976
    ds_read_b64_tr_b16 v[98:99], v148 offset:31744
    v_mfma_f32_32x32x16_bf16 v[16:31], v[108:111], v[132:135], v[16:31]
    ds_read_b128 v[124:127], v146 offset:20480
    ds_read_b64_tr_b16 v[100:101], v148 offset:31008
    ds_read_b64_tr_b16 v[102:103], v148 offset:31776
    v_mfma_f32_32x32x16_bf16 v[32:47], v[112:115], v[128:131], v[32:47]
    ds_read_b64_tr_b16 v[104:105], v148 offset:31040
    ds_read_b64_tr_b16 v[106:107], v148 offset:31808
    v_mfma_f32_32x32x16_bf16 v[48:63], v[112:115], v[132:135], v[48:63]
    buffer_load_dwordx4 v141, s[12:15], s31 offen offset:1024 lds
    v_mfma_f32_32x32x16_bf16 v[64:79], v[116:119], v[128:131], v[64:79]
    buffer_load_dwordx4 v142, s[12:15], s31 offen offset:2048 lds
    v_mfma_f32_32x32x16_bf16 v[80:95], v[116:119], v[132:135], v[80:95]
    s_waitcnt lgkmcnt(0)
    v_mfma_f32_32x32x16_bf16 v[0:15], v[96:99], v[120:123], v[0:15]
    ds_read_b128 v[128:131], v147 offset:16384
    ds_read_b64_tr_b16 v[108:109], v148 offset:34048
    ds_read_b64_tr_b16 v[110:111], v148 offset:34816
    v_mfma_f32_32x32x16_bf16 v[16:31], v[96:99], v[124:127], v[16:31]
    ds_read_b128 v[132:135], v147 offset:20480
    ds_read_b64_tr_b16 v[112:113], v148 offset:34080
    ds_read_b64_tr_b16 v[114:115], v148 offset:34848
    v_mfma_f32_32x32x16_bf16 v[32:47], v[100:103], v[120:123], v[32:47]
    ds_read_b64_tr_b16 v[116:117], v148 offset:34112
    ds_read_b64_tr_b16 v[118:119], v148 offset:34880
    v_mfma_f32_32x32x16_bf16 v[48:63], v[100:103], v[124:127], v[48:63]
    s_add_u32 m0, s33, 12320
    s_nop 0
    buffer_load_dwordx4 v140, s[16:19], s31 offen offset:0 lds
    v_mfma_f32_32x32x16_bf16 v[64:79], v[104:107], v[120:123], v[64:79]
    buffer_load_dwordx4 v141, s[16:19], s31 offen offset:1024 lds
    v_mfma_f32_32x32x16_bf16 v[80:95], v[104:107], v[124:127], v[80:95]
    buffer_load_dwordx4 v142, s[16:19], s31 offen offset:2048 lds
    s_add_u32 s34, s34, 1
    s_cmp_eq_u32 s34, 10
    s_cselect_b32 s28, 1280, 0
    s_cselect_b32 s29, 1966080, 0
    s_cselect_b32 s34, 0, s34
    s_add_u32 s30, s30, 128
    s_add_u32 s31, s31, 196608
    s_sub_u32 s30, s30, s28
    s_sub_u32 s31, s31, s29
    s_waitcnt vmcnt(10) lgkmcnt(0)
    s_barrier
    v_mfma_f32_32x32x16_bf16 v[0:15], v[108:111], v[128:131], v[0:15]
    ds_read_b128 v[120:123], v144 offset:32768
    ds_read_b64_tr_b16 v[96:97], v148 offset:49664
    ds_read_b64_tr_b16 v[98:99], v148 offset:50432
    v_mfma_f32_32x32x16_bf16 v[16:31], v[108:111], v[132:135], v[16:31]
    ds_read_b128 v[124:127], v144 offset:36864
    ds_read_b64_tr_b16 v[100:101], v148 offset:49696
    ds_read_b64_tr_b16 v[102:103], v148 offset:50464
    v_mfma_f32_32x32x16_bf16 v[32:47], v[112:115], v[128:131], v[32:47]
    ds_read_b64_tr_b16 v[104:105], v148 offset:49728
    ds_read_b64_tr_b16 v[106:107], v148 offset:50496
    v_mfma_f32_32x32x16_bf16 v[48:63], v[112:115], v[132:135], v[48:63]
    s_add_u32 m0, s32, 16384
    s_nop 0
    buffer_load_dwordx4 v136, s[8:11], s30 offen offset:0 lds
    v_mfma_f32_32x32x16_bf16 v[64:79], v[116:119], v[128:131], v[64:79]
    buffer_load_dwordx4 v137, s[8:11], s30 offen offset:1024 lds
    v_mfma_f32_32x32x16_bf16 v[80:95], v[116:119], v[132:135], v[80:95]
    s_waitcnt lgkmcnt(0)
    v_mfma_f32_32x32x16_bf16 v[0:15], v[96:99], v[120:123], v[0:15]
    ds_read_b128 v[128:131], v145 offset:32768
    ds_read_b64_tr_b16 v[108:109], v148 offset:52736
    ds_read_b64_tr_b16 v[110:111], v148 offset:53504
    v_mfma_f32_32x32x16_bf16 v[16:31], v[96:99], v[124:127], v[16:31]
    ds_read_b128 v[132:135], v145 offset:36864
    ds_read_b64_tr_b16 v[112:113], v148 offset:52768
    ds_read_b64_tr_b16 v[114:115], v148 offset:53536
    v_mfma_f32_32x32x16_bf16 v[32:47], v[100:103], v[120:123], v[32:47]
    ds_read_b64_tr_b16 v[116:117], v148 offset:52800
    ds_read_b64_tr_b16 v[118:119], v148 offset:53568
    v_mfma_f32_32x32x16_bf16 v[48:63], v[100:103], v[124:127], v[48:63]
    buffer_load_dwordx4 v138, s[8:11], s30 offen offset:2048 lds
    v_mfma_f32_32x32x16_bf16 v[64:79], v[104:107], v[120:123], v[64:79]
    buffer_load_dwordx4 v139, s[8:11], s30 offen offset:3072 lds
    v_mfma_f32_32x32x16_bf16 v[80:95], v[104:107], v[124:127], v[80:95]
    s_add_u32 m0, s33, 24832
    s_nop 0
    buffer_load_dwordx4 v140, s[12:15], s31 offen offset:0 lds
    s_waitcnt lgkmcnt(0)
    v_mfma_f32_32x32x16_bf16 v[0:15], v[108:111], v[128:131], v[0:15]
    ds_read_b128 v[120:123], v146 offset:32768
    ds_read_b64_tr_b16 v[96:97], v148 offset:55808
    ds_read_b64_tr_b16 v[98:99], v148 offset:56576
    v_mfma_f32_32x32x16_bf16 v[16:31], v[108:111], v[132:135], v[16:31]
    ds_read_b128 v[124:127], v146 offset:36864
    ds_read_b64_tr_b16 v[100:101], v148 offset:55840
    ds_read_b64_tr_b16 v[102:103], v148 offset:56608
    v_mfma_f32_32x32x16_bf16 v[32:47], v[112:115], v[128:131], v[32:47]
    ds_read_b64_tr_b16 v[104:105], v148 offset:55872
    ds_read_b64_tr_b16 v[106:107], v148 offset:56640
    v_mfma_f32_32x32x16_bf16 v[48:63], v[112:115], v[132:135], v[48:63]
    buffer_load_dwordx4 v141, s[12:15], s31 offen offset:1024 lds
    v_mfma_f32_32x32x16_bf16 v[64:79], v[116:119], v[128:131], v[64:79]
    buffer_load_dwordx4 v142, s[12:15], s31 offen offset:2048 lds
    v_mfma_f32_32x32x16_bf16 v[80:95], v[116:119], v[132:135], v[80:95]
    s_waitcnt lgkmcnt(0)
    v_mfma_f32_32x32x16_bf16 v[0:15], v[96:99], v[120:123], v[0:15]
    ds_read_b128 v[128:131], v147 offset:32768
    ds_read_b64_tr_b16 v[108:109], v148 offset:58880
    ds_read_b64_tr_b16 v[110:111], v148 offset:59648
    v_mfma_f32_32x32x16_bf16 v[16:31], v[96:99], v[124:127], v[16:31]
    ds_read_b128 v[132:135], v147 offset:36864
    ds_read_b64_tr_b16 v[112:113], v148 offset:58912
    ds_read_b64_tr_b16 v[114:115], v148 offset:59680
    v_mfma_f32_32x32x16_bf16 v[32:47], v[100:103], v[120:123], v[32:47]
    ds_read_b64_tr_b16 v[116:117], v148 offset:58944
    ds_read_b64_tr_b16 v[118:119], v148 offset:59712
    v_mfma_f32_32x32x16_bf16 v[48:63], v[100:103], v[124:127], v[48:63]
    s_add_u32 m0, s33, 37152
    s_nop 0
    buffer_load_dwordx4 v140, s[16:19], s31 offen offset:0 lds
    v_mfma_f32_32x32x16_bf16 v[64:79], v[104:107], v[120:123], v[64:79]
    buffer_load_dwordx4 v141, s[16:19], s31 offen offset:1024 lds
    v_mfma_f32_32x32x16_bf16 v[80:95], v[104:107], v[124:127], v[80:95]
    buffer_load_dwordx4 v142, s[16:19], s31 offen offset:2048 lds
    s_add_u32 s34, s34, 1
    s_cmp_eq_u32 s34, 10
    s_cselect_b32 s28, 1280, 0
    s_cselect_b32 s29, 1966080, 0
    s_cselect_b32 s34, 0, s34
    s_add_u32 s30, s30, 128
    s_add_u32 s31, s31, 196608
    s_sub_u32 s30, s30, s28
    s_sub_u32 s31, s31, s29
    s_waitcnt vmcnt(10) lgkmcnt(0)
    s_barrier
    v_mfma_f32_32x32x16_bf16 v[0:15], v[108:111], v[128:131], v[0:15]
    ds_read_b128 v[120:123], v144 offset:0
    ds_read_b64_tr_b16 v[96:97], v148 offset:0
    ds_read_b64_tr_b16 v[98:99], v148 offset:768
    v_mfma_f32_32x32x16_bf16 v[16:31], v[108:111], v[132:135], v[16:31]
    ds_read_b128 v[124:127], v144 offset:4096
    ds_read_b64_tr_b16 v[100:101], v148 offset:32
    ds_read_b64_tr_b16 v[102:103], v148 offset:800
    v_mfma_f32_32x32x16_bf16 v[32:47], v[112:115], v[128:131], v[32:47]
    ds_read_b64_tr_b16 v[104:105], v148 offset:64
    ds_read_b64_tr_b16 v[106:107], v148 offset:832
    v_mfma_f32_32x32x16_bf16 v[48:63], v[112:115], v[132:135], v[48:63]
    s_add_u32 m0, s32, 32768
    s_nop 0
    buffer_load_dwordx4 v136, s[8:11], s30 offen offset:0 lds
    v_mfma_f32_32x32x16_bf16 v[64:79], v[116:119], v[128:131], v[64:79]
    buffer_load_dwordx4 v137, s[8:11], s30 offen offset:1024 lds
    v_mfma_f32_32x32x16_bf16 v[80:95], v[116:119], v[132:135], v[80:95]
    s_waitcnt lgkmcnt(0)
    v_mfma_f32_32x32x16_bf16 v[0:15], v[96:99], v[120:123], v[0:15]
    ds_read_b128 v[128:131], v145 offset:0
    ds_read_b64_tr_b16 v[108:109], v148 offset:3072
    ds_read_b64_tr_b16 v[110:111], v148 offset:3840
    v_mfma_f32_32x32x16_bf16 v[16:31], v[96:99], v[124:127], v[16:31]
    ds_read_b128 v[132:135], v145 offset:4096
    ds_read_b64_tr_b16 v[112:113], v148 offset:3104
    ds_read_b64_tr_b16 v[114:115], v148 offset:3872
    v_mfma_f32_32x32x16_bf16 v[32:47], v[100:103], v[120:123], v[32:47]
    ds_read_b64_tr_b16 v[116:117], v148 offset:3136
    ds_read_b64_tr_b16 v[118:119], v148 offset:3904
    v_mfma_f32_32x32x16_bf16 v[48:63], v[100:103], v[124:127], v[48:63]
    buffer_load_dwordx4 v138, s[8:11], s30 offen offset:2048 lds
    v_mfma_f32_32x32x16_bf16 v[64:79], v[104:107], v[120:123], v[64:79]
    buffer_load_dwordx4 v139, s[8:11], s30 offen offset:3072 lds
    v_mfma_f32_32x32x16_bf16 v[80:95], v[104:107], v[124:127], v[80:95]
    s_add_u32 m0, s33, 49664
    s_nop 0
    buffer_load_dwordx4 v140, s[12:15], s31 offen offset:0 lds
    s_waitcnt lgkmcnt(0)
    v_mfma_f32_32x32x16_bf16 v[0:15], v[108:111], v[128:131], v[0:15]
    ds_read_b128 v[120:123], v146 offset:0
    ds_read_b64_tr_b16 v[96:97], v148 offset:6144
    ds_read_b64_tr_b16 v[98:99], v148 offset:6912
    v_mfma_f32_32x32x16_bf16 v[16:31], v[108:111], v[132:135], v[16:31]
    ds_read_b128 v[124:127], v146 offset:4096
    ds_read_b64_tr_b16 v[100:101], v148 offset:6176
    ds_read_b64_tr_b16 v[102:103], v148 offset:6944
    v_mfma_f32_32x32x16_bf16 v[32:47], v[112:115], v[128:131], v[32:47]
    ds_read_b64_tr_b16 v[104:105], v148 offset:6208
    ds_read_b64_tr_b16 v[106:107], v148 offset:6976
    v_mfma_f32_32x32x16_bf16 v[48:63], v[112:115], v[132:135], v[48:63]
    buffer_load_dwordx4 v141, s[12:15], s31 offen offset:1024 lds
    v_mfma_f32_32x32x16_bf16 v[64:79], v[116:119], v[128:131], v[64:79]
    buffer_load_dwordx4 v142, s[12:15], s31 offen offset:2048 lds
    v_mfma_f32_32x32x16_bf16 v[80:95], v[116:119], v[132:135], v[80:95]
    s_waitcnt lgkmcnt(0)
    v_mfma_f32_32x32x16_bf16 v[0:15], v[96:99], v[120:123], v[0:15]
    ds_read_b128 v[128:131], v147 offset:0
    ds_read_b64_tr_b16 v[108:109], v148 offset:9216
    ds_read_b64_tr_b16 v[110:111], v148 offset:9984
    v_mfma_f32_32x32x16_bf16 v[16:31], v[96:99], v[124:127], v[16:31]
    ds_read_b128 v[132:135], v147 offset:4096
    ds_read_b64_tr_b16 v[112:113], v148 offset:9248
    ds_read_b64_tr_b16 v[114:115], v148 offset:10016
    v_mfma_f32_32x32x16_bf16 v[32:47], v[100:103], v[120:123], v[32:47]
    ds_read_b64_tr_b16 v[116:117], v148 offset:9280
    ds_read_b64_tr_b16 v[118:119], v148 offset:10048
    v_mfma_f32_32x32x16_bf16 v[48:63], v[100:103], v[124:127], v[48:63]
    s_add_u32 m0, s33, 61984
    s_nop 0
    buffer_load_dwordx4 v140, s[16:19], s31 offen offset:0 lds
    v_mfma_f32_32x32x16_bf16 v[64:79], v[104:107], v[120:123], v[64:79]
    buffer_load_dwordx4 v141, s[16:19], s31 offen offset:1024 lds
    v_mfma_f32_32x32x16_bf16 v[80:95], v[104:107], v[124:127], v[80:95]
    buffer_load_dwordx4 v142, s[16:19], s31 offen offset:2048 lds
    s_add_u32 s34, s34, 1
    s_cmp_eq_u32 s34, 10
    s_cselect_b32 s28, 1280, 0
    s_cselect_b32 s29, 1966080, 0
    s_cselect_b32 s34, 0, s34
    s_add_u32 s30, s30, 128
    s_add_u32 s31, s31, 196608
    s_sub_u32 s30, s30, s28
    s_sub_u32 s31, s31, s29
    s_waitcnt vmcnt(10) lgkmcnt(0)
    s_barrier
    v_mfma_f32_32x32x16_bf16 v[0:15], v[108:111], v[128:131], v[0:15]
    ds_read_b128 v[120:123], v144 offset:16384
    ds_read_b64_tr_b16 v[96:97], v148 offset:24832
    ds_read_b64_tr_b16 v[98:99], v148 offset:25600
    v_mfma_f32_32x32x16_bf16 v[16:31], v[108:111], v[132:135], v[16:31]
    ds_read_b128 v[124:127], v144 offset:20480
    ds_read_b64_tr_b16 v[100:101], v148 offset:24864
    ds_read_b64_tr_b16 v[102:103], v148 offset:25632
    v_mfma_f32_32x32x16_bf16 v[32:47], v[112:115], v[128:131], v[32:47]
    ds_read_b64_tr_b16 v[104:105], v148 offset:24896
    ds_read_b64_tr_b16 v[106:107], v148 offset:25664
    v_mfma_f32_32x32x16_bf16 v[48:63], v[112:115], v[132:135], v[48:63]
    s_add_u32 m0, s32, 0
    s_nop 0
    buffer_load_dwordx4 v136, s[8:11], s30 offen offset:0 lds
    v_mfma_f32_32x32x16_bf16 v[64:79], v[116:119], v[128:131], v[64:79]
    buffer_load_dwordx4 v137, s[8:11], s30 offen offset:1024 lds
    v_mfma_f32_32x32x16_bf16 v[80:95], v[116:119], v[132:135], v[80:95]
    s_waitcnt lgkmcnt(0)
    v_mfma_f32_32x32x16_bf16 v[0:15], v[96:99], v[120:123], v[0:15]
    ds_read_b128 v[128:131], v145 offset:16384
    ds_read_b64_tr_b16 v[108:109], v148 offset:27904
    ds_read_b64_tr_b16 v[110:111], v148 offset:28672
    v_mfma_f32_32x32x16_bf16 v[16:31], v[96:99], v[124:127], v[16:31]
    ds_read_b128 v[132:135], v145 offset:20480
    ds_read_b64_tr_b16 v[112:113], v148 offset:27936
    ds_read_b64_tr_b16 v[114:115], v148 offset:28704
    v_mfma_f32_32x32x16_bf16 v[32:47], v[100:103], v[120:123], v[32:47]
    ds_read_b64_tr_b16 v[116:117], v148 offset:27968
    ds_read_b64_tr_b16 v[118:119], v148 offset:28736
    v_mfma_f32_32x32x16_bf16 v[48:63], v[100:103], v[124:127], v[48:63]
    buffer_load_dwordx4 v138, s[8:11], s30 offen offset:2048 lds
    v_mfma_f32_32x32x16_bf16 v[64:79], v[104:107], v[120:123], v[64:79]
    buffer_load_dwordx4 v139, s[8:11], s30 offen offset:3072 lds
    v_mfma_f32_32x32x16_bf16 v[80:95], v[104:107], v[124:127], v[80:95]
    s_add_u32 m0, s33, 0
    s_nop 0
    buffer_load_dwordx4 v140, s[12:15], s31 offen offset:0 lds
    s_waitcnt lgkmcnt(0)
    v_mfma_f32_32x32x16_bf16 v[0:15], v[108:111], v[128:131], v[0:15]
    ds_read_b128 v[120:123], v146 offset:16384
    ds_read_b64_tr_b16 v[96:97], v148 offset:30976
    ds_read_b64_tr_b16 v[98:99], v148 offset:31744
    v_mfma_f32_32x32x16_bf16 v[16:31], v[108:111], v[132:135], v[16:31]
    ds_read_b128 v[124:127], v146 offset:20480
    ds_read_b64_tr_b16 v[100:101], v148 offset:31008
    ds_read_b64_tr_b16 v[102:103], v148 offset:31776
    v_mfma_f32_32x32x16_bf16 v[32:47], v[112:115], v[128:131], v[32:47]
    ds_read_b64_tr_b16 v[104:105], v148 offset:31040
    ds_read_b64_tr_b16 v[106:107], v148 offset:31808
    v_mfma_f32_32x32x16_bf16 v[48:63], v[112:115], v[132:135], v[48:63]
    buffer_load_dwordx4 v141, s[12:15], s31 offen offset:1024 lds
    v_mfma_f32_32x32x16_bf16 v[64:79], v[116:119], v[128:131], v[64:79]
    buffer_load_dwordx4 v142, s[12:15], s31 offen offset:2048 lds
    v_mfma_f32_32x32x16_bf16 v[80:95], v[116:119], v[132:135], v[80:95]
    s_waitcnt lgkmcnt(0)
    v_mfma_f32_32x32x16_bf16 v[0:15], v[96:99], v[120:123], v[0:15]
    ds_read_b128 v[128:131], v147 offset:16384
    ds_read_b64_tr_b16 v[108:109], v148 offset:34048
    ds_read_b64_tr_b16 v[110:111], v148 offset:34816
    v_mfma_f32_32x32x16_bf16 v[16:31], v[96:99], v[124:127], v[16:31]
    ds_read_b128 v[132:135], v147 offset:20480
    ds_read_b64_tr_b16 v[112:113], v148 offset:34080
    ds_read_b64_tr_b16 v[114:115], v148 offset:34848
    v_mfma_f32_32x32x16_bf16 v[32:47], v[100:103], v[120:123], v[32:47]
    ds_read_b64_tr_b16 v[116:117], v148 offset:34112
    ds_read_b64_tr_b16 v[118:119], v148 offset:34880
    v_mfma_f32_32x32x16_bf16 v[48:63], v[100:103], v[124:127], v[48:63]
    s_add_u32 m0, s33, 12320
    s_nop 0
    buffer_load_dwordx4 v140, s[16:19], s31 offen offset:0 lds
    v_mfma_f32_32x32x16_bf16 v[64:79], v[104:107], v[120:123], v[64:79]
    buffer_load_dwordx4 v141, s[16:19], s31 offen offset:1024 lds
    v_mfma_f32_32x32x16_bf16 v[80:95], v[104:107], v[124:127], v[80:95]
    buffer_load_dwordx4 v142, s[16:19], s31 offen offset:2048 lds
    s_add_u32 s34, s34, 1
    s_cmp_eq_u32 s34, 10
    s_cselect_b32 s28, 1280, 0
    s_cselect_b32 s29, 1966080, 0
    s_cselect_b32 s34, 0, s34
    s_add_u32 s30, s30, 128
    s_add_u32 s31, s31, 196608
    s_sub_u32 s30, s30, s28
    s_sub_u32 s31, s31, s29
    s_waitcnt vmcnt(10) lgkmcnt(0)
    s_barrier
    v_mfma_f32_32x32x16_bf16 v[0:15], v[108:111], v[128:131], v[0:15]
    ds_read_b128 v[120:123], v144 offset:32768
    ds_read_b64_tr_b16 v[96:97], v148 offset:49664
    ds_read_b64_tr_b16 v[98:99], v148 offset:50432
    v_mfma_f32_32x32x16_bf16 v[16:31], v[108:111], v[132:135], v[16:31]
    ds_read_b128 v[124:127], v144 offset:36864
    ds_read_b64_tr_b16 v[100:101], v148 offset:49696
    ds_read_b64_tr_b16 v[102:103], v148 offset:50464
    v_mfma_f32_32x32x16_bf16 v[32:47], v[112:115], v[128:131], v[32:47]
    ds_read_b64_tr_b16 v[104:105], v148 offset:49728
    ds_read_b64_tr_b16 v[106:107], v148 offset:50496
    v_mfma_f32_32x32x16_bf16 v[48:63], v[112:115], v[132:135], v[48:63]
    v_mfma_f32_32x32x16_bf16 v[64:79], v[116:119], v[128:131], v[64:79]
    v_mfma_f32_32x32x16_bf16 v[80:95], v[116:119], v[132:135], v[80:95]
    s_waitcnt lgkmcnt(0)
    v_mfma_f32_32x32x16_bf16 v[0:15], v[96:99], v[120:123], v[0:15]
    ds_read_b128 v[128:131], v145 offset:32768
    ds_read_b64_tr_b16 v[108:109], v148 offset:52736
    ds_read_b64_tr_b16 v[110:111], v148 offset:53504
    v_mfma_f32_32x32x16_bf16 v[16:31], v[96:99], v[124:127], v[16:31]
    ds_read_b128 v[132:135], v145 offset:36864
    ds_read_b64_tr_b16 v[112:113], v148 offset:52768
    ds_read_b64_tr_b16 v[114:115], v148 offset:53536
    v_mfma_f32_32x32x16_bf16 v[32:47], v[100:103], v[120:123], v[32:47]
    ds_read_b64_tr_b16 v[116:117], v148 offset:52800
    ds_read_b64_tr_b16 v[118:119], v148 offset:53568
    v_mfma_f32_32x32x16_bf16 v[48:63], v[100:103], v[124:127], v[48:63]
    v_mfma_f32_32x32x16_bf16 v[64:79], v[104:107], v[120:123], v[64:79]
    v_mfma_f32_32x32x16_bf16 v[80:95], v[104:107], v[124:127], v[80:95]
    s_waitcnt lgkmcnt(0)
    v_mfma_f32_32x32x16_bf16 v[0:15], v[108:111], v[128:131], v[0:15]
    ds_read_b128 v[120:123], v146 offset:32768
    ds_read_b64_tr_b16 v[96:97], v148 offset:55808
    ds_read_b64_tr_b16 v[98:99], v148 offset:56576
    v_mfma_f32_32x32x16_bf16 v[16:31], v[108:111], v[132:135], v[16:31]
    ds_read_b128 v[124:127], v146 offset:36864
    ds_read_b64_tr_b16 v[100:101], v148 offset:55840
    ds_read_b64_tr_b16 v[102:103], v148 offset:56608
    v_mfma_f32_32x32x16_bf16 v[32:47], v[112:115], v[128:131], v[32:47]
    ds_read_b64_tr_b16 v[104:105], v148 offset:55872
    ds_read_b64_tr_b16 v[106:107], v148 offset:56640
    v_mfma_f32_32x32x16_bf16 v[48:63], v[112:115], v[132:135], v[48:63]
    v_mfma_f32_32x32x16_bf16 v[64:79], v[116:119], v[128:131], v[64:79]
    v_mfma_f32_32x32x16_bf16 v[80:95], v[116:119], v[132:135], v[80:95]
    s_waitcnt lgkmcnt(0)
    v_mfma_f32_32x32x16_bf16 v[0:15], v[96:99], v[120:123], v[0:15]
    ds_read_b128 v[128:131], v147 offset:32768
    ds_read_b64_tr_b16 v[108:109], v148 offset:58880
    ds_read_b64_tr_b16 v[110:111], v148 offset:59648
    v_mfma_f32_32x32x16_bf16 v[16:31], v[96:99], v[124:127], v[16:31]
    ds_read_b128 v[132:135], v147 offset:36864
    ds_read_b64_tr_b16 v[112:113], v148 offset:58912
    ds_read_b64_tr_b16 v[114:115], v148 offset:59680
    v_mfma_f32_32x32x16_bf16 v[32:47], v[100:103], v[120:123], v[32:47]
    ds_read_b64_tr_b16 v[116:117], v148 offset:58944
    ds_read_b64_tr_b16 v[118:119], v148 offset:59712
    v_mfma_f32_32x32x16_bf16 v[48:63], v[100:103], v[124:127], v[48:63]
    v_mfma_f32_32x32x16_bf16 v[64:79], v[104:107], v[120:123], v[64:79]
    v_mfma_f32_32x32x16_bf16 v[80:95], v[104:107], v[124:127], v[80:95]
    s_waitcnt vmcnt(0) lgkmcnt(0)
    s_barrier
    v_mfma_f32_32x32x16_bf16 v[0:15], v[108:111], v[128:131], v[0:15]
    ds_read_b128 v[120:123], v144 offset:0
    ds_read_b64_tr_b16 v[96:97], v148 offset:0
    ds_read_b64_tr_b16 v[98:99], v148 offset:768
    v_mfma_f32_32x32x16_bf16 v[16:31], v[108:111], v[132:135], v[16:31]
    ds_read_b128 v[124:127], v144 offset:4096
    ds_read_b64_tr_b16 v[100:101], v148 offset:32
    ds_read_b64_tr_b16 v[102:103], v148 offset:800
    v_mfma_f32_32x32x16_bf16 v[32:47], v[112:115], v[128:131], v[32:47]
    ds_read_b64_tr_b16 v[104:105], v148 offset:64
    ds_read_b64_tr_b16 v[106:107], v148 offset:832
    v_mfma_f32_32x32x16_bf16 v[48:63], v[112:115], v[132:135], v[48:63]
    v_mfma_f32_32x32x16_bf16 v[64:79], v[116:119], v[128:131], v[64:79]
    v_mfma_f32_32x32x16_bf16 v[80:95], v[116:119], v[132:135], v[80:95]
    s_waitcnt lgkmcnt(0)
    v_mfma_f32_32x32x16_bf16 v[0:15], v[96:99], v[120:123], v[0:15]
    ds_read_b128 v[128:131], v145 offset:0
    ds_read_b64_tr_b16 v[108:109], v148 offset:3072
    ds_read_b64_tr_b16 v[110:111], v148 offset:3840
    v_mfma_f32_32x32x16_bf16 v[16:31], v[96:99], v[124:127], v[16:31]
    ds_read_b128 v[132:135], v145 offset:4096
    ds_read_b64_tr_b16 v[112:113], v148 offset:3104
    ds_read_b64_tr_b16 v[114:115], v148 offset:3872
    v_mfma_f32_32x32x16_bf16 v[32:47], v[100:103], v[120:123], v[32:47]
    ds_read_b64_tr_b16 v[116:117], v148 offset:3136
    ds_read_b64_tr_b16 v[118:119], v148 offset:3904
    v_mfma_f32_32x32x16_bf16 v[48:63], v[100:103], v[124:127], v[48:63]
    v_mfma_f32_32x32x16_bf16 v[64:79], v[104:107], v[120:123], v[64:79]
    v_mfma_f32_32x32x16_bf16 v[80:95], v[104:107], v[124:127], v[80:95]
    s_waitcnt lgkmcnt(0)
    v_mfma_f32_32x32x16_bf16 v[0:15], v[108:111], v[128:131], v[0:15]
    ds_read_b128 v[120:123], v146 offset:0
    ds_read_b64_tr_b16 v[96:97], v148 offset:6144
    ds_read_b64_tr_b16 v[98:99], v148 offset:6912
    v_mfma_f32_32x32x16_bf16 v[16:31], v[108:111], v[132:135], v[16:31]
    ds_read_b128 v[124:127], v146 offset:4096
    ds_read_b64_tr_b16 v[100:101], v148 offset:6176
    ds_read_b64_tr_b16 v[102:103], v148 offset:6944
    v_mfma_f32_32x32x16_bf16 v[32:47], v[112:115], v[128:131], v[32:47]
    ds_read_b64_tr_b16 v[104:105], v148 offset:6208
    ds_read_b64_tr_b16 v[106:107], v148 offset:6976
    v_mfma_f32_32x32x16_bf16 v[48:63], v[112:115], v[132:135], v[48:63]
    v_mfma_f32_32x32x16_bf16 v[64:79], v[116:119], v[128:131], v[64:79]
    v_mfma_f32_32x32x16_bf16 v[80:95], v[116:119], v[132:135], v[80:95]
    s_waitcnt lgkmcnt(0)
    v_mfma_f32_32x32x16_bf16 v[0:15], v[96:99], v[120:123], v[0:15]
    ds_read_b128 v[128:131], v147 offset:0
    ds_read_b64_tr_b16 v[108:109], v148 offset:9216
    ds_read_b64_tr_b16 v[110:111], v148 offset:9984
    v_mfma_f32_32x32x16_bf16 v[16:31], v[96:99], v[124:127], v[16:31]
    ds_read_b128 v[132:135], v147 offset:4096
    ds_read_b64_tr_b16 v[112:113], v148 offset:9248
    ds_read_b64_tr_b16 v[114:115], v148 offset:10016
    v_mfma_f32_32x32x16_bf16 v[32:47], v[100:103], v[120:123], v[32:47]
    ds_read_b64_tr_b16 v[116:117], v148 offset:9280
    ds_read_b64_tr_b16 v[118:119], v148 offset:10048
    v_mfma_f32_32x32x16_bf16 v[48:63], v[100:103], v[124:127], v[48:63]
    v_mfma_f32_32x32x16_bf16 v[64:79], v[104:107], v[120:123], v[64:79]
    v_mfma_f32_32x32x16_bf16 v[80:95], v[104:107], v[124:127], v[80:95]
    s_waitcnt lgkmcnt(0)
    v_mfma_f32_32x32x16_bf16 v[0:15], v[108:111], v[128:131], v[0:15]
    v_mfma_f32_32x32x16_bf16 v[16:31], v[108:111], v[132:135], v[16:31]
    v_mfma_f32_32x32x16_bf16 v[32:47], v[112:115], v[128:131], v[32:47]
    v_mfma_f32_32x32x16_bf16 v[48:63], v[112:115], v[132:135], v[48:63]
    v_mfma_f32_32x32x16_bf16 v[64:79], v[116:119], v[128:131], v[64:79]
    v_mfma_f32_32x32x16_bf16 v[80:95], v[116:119], v[132:135], v[80:95]
    s_barrier
    v_and_b32 v150, 31, v149
    s_lshl_b32 s28, s27, 6
    v_add_u32 v150, s28, v150
    v_lshlrev_b32 v150, 3, v150
    v_add_u32 v150, 123648, v150
    v_lshrrev_b32 v151, 5, v149
    v_lshlrev_b32 v151, 4, v151
    s_mul_i32 s29, s26, 192
    s_add_u32 s29, s29, 124672
    v_add_u32 v151, s29, v151
    ds_read_b64 v[160:161], v150 offset:0
    ds_read_b64 v[162:163], v150 offset:256
    ds_read_b128 v[168:171], v151 offset:0
    ds_read_b128 v[172:175], v151 offset:384
    ds_read_b128 v[176:179], v151 offset:32
    ds_read_b128 v[180:183], v151 offset:416
    ds_read_b128 v[184:187], v151 offset:64
    ds_read_b128 v[188:191], v151 offset:448
    ds_read_b128 v[192:195], v151 offset:96
    ds_read_b128 v[196:199], v151 offset:480
    ds_read_b128 v[200:203], v151 offset:128
    ds_read_b128 v[204:207], v151 offset:512
    ds_read_b128 v[208:211], v151 offset:160
    ds_read_b128 v[212:215], v151 offset:544
    v_and_b32 v150, 15, v149
    v_bfe_u32 v152, v149, 4, 1
    v_mul_u32_u24 v152, 49152, v152
    v_lshl_add_u32 v152, v150, 4, v152
    v_lshrrev_b32 v150, 5, v149
    v_lshl_add_u32 v216, v150, 8, v152
    s_lshl_b32 s28, s22, 3
    s_lshl_b32 s29, s27, 2
    s_add_u32 s28, s28, s29
    s_mul_i32 s28, s28, 48
    s_mul_i32 s29, s23, 3
    s_add_u32 s28, s28, s29
    s_lshl_b32 s28, s28, 10
    s_add_u32 s60, s28, 0
    s_mul_i32 s28, s26, 1536
    s_add_u32 s28, s28, 0
    s_add_u32 s61, s28, s60
    s_mul_i32 s28, s26, 1536
    s_add_u32 s28, s28, 512
    s_add_u32 s62, s28, s60
    s_mul_i32 s28, s26, 1536
    s_add_u32 s28, s28, 1024
    s_add_u32 s63, s28, s60
    s_waitcnt lgkmcnt(0)
    v_mul_f32 v234, 0xbfb8aa3b, v161
    v_mul_f32 v236, v161, v161
    v_sub_f32 v160, 0, v160
    v_mul_f32 v238, 0xbfb8aa3b, v163
    v_mul_f32 v240, v163, v163
    v_sub_f32 v162, 0, v162
    v_pk_fma_f32 v[0:1], v[160:161], v[168:169], v[0:1] op_sel_hi:[0,1,1]
    v_pk_fma_f32 v[2:3], v[160:161], v[170:171], v[2:3] op_sel_hi:[0,1,1]
    v_pk_fma_f32 v[8:9], v[160:161], v[176:177], v[8:9] op_sel_hi:[0,1,1]
    v_pk_fma_f32 v[10:11], v[160:161], v[178:179], v[10:11] op_sel_hi:[0,1,1]
    v_pk_mul_f32 v[218:219], v[0:1], v[234:235] op_sel_hi:[1,0]
    v_pk_mul_f32 v[220:221], v[2:3], v[234:235] op_sel_hi:[1,0]
    v_pk_mul_f32 v[222:223], v[8:9], v[234:235] op_sel_hi:[1,0]
    v_pk_mul_f32 v[224:225], v[10:11], v[234:235] op_sel_hi:[1,0]
    v_pk_fma_f32 v[4:5], v[160:161], v[172:173], v[4:5] op_sel_hi:[0,1,1]
    v_pk_fma_f32 v[6:7], v[160:161], v[174:175], v[6:7] op_sel_hi:[0,1,1]
    v_pk_fma_f32 v[12:13], v[160:161], v[180:181], v[12:13] op_sel_hi:[0,1,1]
    v_pk_fma_f32 v[14:15], v[160:161], v[182:183], v[14:15] op_sel_hi:[0,1,1]
    v_exp_f32 v218, v218
    v_exp_f32 v219, v219
    v_exp_f32 v220, v220
    v_exp_f32 v221, v221
    v_exp_f32 v222, v222
    v_exp_f32 v223, v223
    v_exp_f32 v224, v224
    v_exp_f32 v225, v225
    v_pk_mul_f32 v[0:1], v[0:1], v[4:5]
    v_pk_mul_f32 v[2:3], v[2:3], v[6:7]
    v_pk_mul_f32 v[8:9], v[8:9], v[12:13]
    v_pk_mul_f32 v[10:11], v[10:11], v[14:15]
    v_pk_add_f32 v[218:219], v[218:219], 1.0 op_sel_hi:[1,0]
    v_pk_add_f32 v[220:221], v[220:221], 1.0 op_sel_hi:[1,0]
    v_pk_add_f32 v[222:223], v[222:223], 1.0 op_sel_hi:[1,0]
    v_pk_add_f32 v[224:225], v[224:225], 1.0 op_sel_hi:[1,0]
    v_pk_mul_f32 v[0:1], v[0:1], v[236:237] op_sel_hi:[1,0]
    v_pk_mul_f32 v[2:3], v[2:3], v[236:237] op_sel_hi:[1,0]
    v_pk_mul_f32 v[8:9], v[8:9], v[236:237] op_sel_hi:[1,0]
    v_pk_mul_f32 v[10:11], v[10:11], v[236:237] op_sel_hi:[1,0]
    v_rcp_f32 v218, v218
    v_rcp_f32 v219, v219
    v_rcp_f32 v220, v220
    v_rcp_f32 v221, v221
    v_rcp_f32 v222, v222
    v_rcp_f32 v223, v223
    v_rcp_f32 v224, v224
    v_rcp_f32 v225, v225
    s_nop 0
    v_pk_mul_f32 v[0:1], v[0:1], v[218:219]
    v_pk_mul_f32 v[2:3], v[2:3], v[220:221]
    v_pk_mul_f32 v[8:9], v[8:9], v[222:223]
    v_pk_mul_f32 v[10:11], v[10:11], v[224:225]
    v_cvt_pk_bf16_f32 v226, v0, v1
    v_cvt_pk_bf16_f32 v227, v2, v3
    v_cvt_pk_bf16_f32 v228, v8, v9
    v_cvt_pk_bf16_f32 v229, v10, v11
    s_add_u32 s28, s61, 0
    s_nop 0
    buffer_store_dwordx4 v[226:229], v216, s[36:39], s28 offen sc1
    v_pk_fma_f32 v[16:17], v[162:163], v[168:169], v[16:17] op_sel_hi:[0,1,1]
    v_pk_fma_f32 v[18:19], v[162:163], v[170:171], v[18:19] op_sel_hi:[0,1,1]
    v_pk_fma_f32 v[24:25], v[162:163], v[176:177], v[24:25] op_sel_hi:[0,1,1]
    v_pk_fma_f32 v[26:27], v[162:163], v[178:179], v[26:27] op_sel_hi:[0,1,1]
    v_pk_mul_f32 v[218:219], v[16:17], v[238:239] op_sel_hi:[1,0]
    v_pk_mul_f32 v[220:221], v[18:19], v[238:239] op_sel_hi:[1,0]
    v_pk_mul_f32 v[222:223], v[24:25], v[238:239] op_sel_hi:[1,0]
    v_pk_mul_f32 v[224:225], v[26:27], v[238:239] op_sel_hi:[1,0]
    v_pk_fma_f32 v[20:21], v[162:163], v[172:173], v[20:21] op_sel_hi:[0,1,1]
    v_pk_fma_f32 v[22:23], v[162:163], v[174:175], v[22:23] op_sel_hi:[0,1,1]
    v_pk_fma_f32 v[28:29], v[162:163], v[180:181], v[28:29] op_sel_hi:[0,1,1]
    v_pk_fma_f32 v[30:31], v[162:163], v[182:183], v[30:31] op_sel_hi:[0,1,1]
    v_exp_f32 v218, v218
    v_exp_f32 v219, v219
    v_exp_f32 v220, v220
    v_exp_f32 v221, v221
    v_exp_f32 v222, v222
    v_exp_f32 v223, v223
    v_exp_f32 v224, v224
    v_exp_f32 v225, v225
    v_pk_mul_f32 v[16:17], v[16:17], v[20:21]
    v_pk_mul_f32 v[18:19], v[18:19], v[22:23]
    v_pk_mul_f32 v[24:25], v[24:25], v[28:29]
    v_pk_mul_f32 v[26:27], v[26:27], v[30:31]
    v_pk_add_f32 v[218:219], v[218:219], 1.0 op_sel_hi:[1,0]
    v_pk_add_f32 v[220:221], v[220:221], 1.0 op_sel_hi:[1,0]
    v_pk_add_f32 v[222:223], v[222:223], 1.0 op_sel_hi:[1,0]
    v_pk_add_f32 v[224:225], v[224:225], 1.0 op_sel_hi:[1,0]
    v_pk_mul_f32 v[16:17], v[16:17], v[240:241] op_sel_hi:[1,0]
    v_pk_mul_f32 v[18:19], v[18:19], v[240:241] op_sel_hi:[1,0]
    v_pk_mul_f32 v[24:25], v[24:25], v[240:241] op_sel_hi:[1,0]
    v_pk_mul_f32 v[26:27], v[26:27], v[240:241] op_sel_hi:[1,0]
    v_rcp_f32 v218, v218
    v_rcp_f32 v219, v219
    v_rcp_f32 v220, v220
    v_rcp_f32 v221, v221
    v_rcp_f32 v222, v222
    v_rcp_f32 v223, v223
    v_rcp_f32 v224, v224
    v_rcp_f32 v225, v225
    s_nop 0
    v_pk_mul_f32 v[16:17], v[16:17], v[218:219]
    v_pk_mul_f32 v[18:19], v[18:19], v[220:221]
    v_pk_mul_f32 v[24:25], v[24:25], v[222:223]
    v_pk_mul_f32 v[26:27], v[26:27], v[224:225]
    v_cvt_pk_bf16_f32 v230, v16, v17
    v_cvt_pk_bf16_f32 v231, v18, v19
    v_cvt_pk_bf16_f32 v232, v24, v25
    v_cvt_pk_bf16_f32 v233, v26, v27
    s_add_u32 s28, s61, 98304
    s_nop 0
    buffer_store_dwordx4 v[230:233], v216, s[36:39], s28 offen sc1
    v_pk_fma_f32 v[32:33], v[160:161], v[184:185], v[32:33] op_sel_hi:[0,1,1]
    v_pk_fma_f32 v[34:35], v[160:161], v[186:187], v[34:35] op_sel_hi:[0,1,1]
    v_pk_fma_f32 v[40:41], v[160:161], v[192:193], v[40:41] op_sel_hi:[0,1,1]
    v_pk_fma_f32 v[42:43], v[160:161], v[194:195], v[42:43] op_sel_hi:[0,1,1]
    v_pk_mul_f32 v[218:219], v[32:33], v[234:235] op_sel_hi:[1,0]
    v_pk_mul_f32 v[220:221], v[34:35], v[234:235] op_sel_hi:[1,0]
    v_pk_mul_f32 v[222:223], v[40:41], v[234:235] op_sel_hi:[1,0]
    v_pk_mul_f32 v[224:225], v[42:43], v[234:235] op_sel_hi:[1,0]
    v_pk_fma_f32 v[36:37], v[160:161], v[188:189], v[36:37] op_sel_hi:[0,1,1]
    v_pk_fma_f32 v[38:39], v[160:161], v[190:191], v[38:39] op_sel_hi:[0,1,1]
    v_pk_fma_f32 v[44:45], v[160:161], v[196:197], v[44:45] op_sel_hi:[0,1,1]
    v_pk_fma_f32 v[46:47], v[160:161], v[198:199], v[46:47] op_sel_hi:[0,1,1]
    v_exp_f32 v218, v218
    v_exp_f32 v219, v219
    v_exp_f32 v220, v220
    v_exp_f32 v221, v221
    v_exp_f32 v222, v222
    v_exp_f32 v223, v223
    v_exp_f32 v224, v224
    v_exp_f32 v225, v225
    v_pk_mul_f32 v[32:33], v[32:33], v[36:37]
    v_pk_mul_f32 v[34:35], v[34:35], v[38:39]
    v_pk_mul_f32 v[40:41], v[40:41], v[44:45]
    v_pk_mul_f32 v[42:43], v[42:43], v[46:47]
    v_pk_add_f32 v[218:219], v[218:219], 1.0 op_sel_hi:[1,0]
    v_pk_add_f32 v[220:221], v[220:221], 1.0 op_sel_hi:[1,0]
    v_pk_add_f32 v[222:223], v[222:223], 1.0 op_sel_hi:[1,0]
    v_pk_add_f32 v[224:225], v[224:225], 1.0 op_sel_hi:[1,0]
    v_pk_mul_f32 v[32:33], v[32:33], v[236:237] op_sel_hi:[1,0]
    v_pk_mul_f32 v[34:35], v[34:35], v[236:237] op_sel_hi:[1,0]
    v_pk_mul_f32 v[40:41], v[40:41], v[236:237] op_sel_hi:[1,0]
    v_pk_mul_f32 v[42:43], v[42:43], v[236:237] op_sel_hi:[1,0]
    v_rcp_f32 v218, v218
    v_rcp_f32 v219, v219
    v_rcp_f32 v220, v220
    v_rcp_f32 v221, v221
    v_rcp_f32 v222, v222
    v_rcp_f32 v223, v223
    v_rcp_f32 v224, v224
    v_rcp_f32 v225, v225
    s_nop 0
    v_pk_mul_f32 v[32:33], v[32:33], v[218:219]
    v_pk_mul_f32 v[34:35], v[34:35], v[220:221]
    v_pk_mul_f32 v[40:41], v[40:41], v[222:223]
    v_pk_mul_f32 v[42:43], v[42:43], v[224:225]
    v_cvt_pk_bf16_f32 v226, v32, v33
    v_cvt_pk_bf16_f32 v227, v34, v35
    v_cvt_pk_bf16_f32 v228, v40, v41
    v_cvt_pk_bf16_f32 v229, v42, v43
    s_add_u32 s28, s62, 0
    s_nop 0
    buffer_store_dwordx4 v[226:229], v216, s[36:39], s28 offen sc1
    v_pk_fma_f32 v[48:49], v[162:163], v[184:185], v[48:49] op_sel_hi:[0,1,1]
    v_pk_fma_f32 v[50:51], v[162:163], v[186:187], v[50:51] op_sel_hi:[0,1,1]
    v_pk_fma_f32 v[56:57], v[162:163], v[192:193], v[56:57] op_sel_hi:[0,1,1]
    v_pk_fma_f32 v[58:59], v[162:163], v[194:195], v[58:59] op_sel_hi:[0,1,1]
    v_pk_mul_f32 v[218:219], v[48:49], v[238:239] op_sel_hi:[1,0]
    v_pk_mul_f32 v[220:221], v[50:51], v[238:239] op_sel_hi:[1,0]
    v_pk_mul_f32 v[222:223], v[56:57], v[238:239] op_sel_hi:[1,0]
    v_pk_mul_f32 v[224:225], v[58:59], v[238:239] op_sel_hi:[1,0]
    v_pk_fma_f32 v[52:53], v[162:163], v[188:189], v[52:53] op_sel_hi:[0,1,1]
    v_pk_fma_f32 v[54:55], v[162:163], v[190:191], v[54:55] op_sel_hi:[0,1,1]
    v_pk_fma_f32 v[60:61], v[162:163], v[196:197], v[60:61] op_sel_hi:[0,1,1]
    v_pk_fma_f32 v[62:63], v[162:163], v[198:199], v[62:63] op_sel_hi:[0,1,1]
    v_exp_f32 v218, v218
    v_exp_f32 v219, v219
    v_exp_f32 v220, v220
    v_exp_f32 v221, v221
    v_exp_f32 v222, v222
    v_exp_f32 v223, v223
    v_exp_f32 v224, v224
    v_exp_f32 v225, v225
    v_pk_mul_f32 v[48:49], v[48:49], v[52:53]
    v_pk_mul_f32 v[50:51], v[50:51], v[54:55]
    v_pk_mul_f32 v[56:57], v[56:57], v[60:61]
    v_pk_mul_f32 v[58:59], v[58:59], v[62:63]
    v_pk_add_f32 v[218:219], v[218:219], 1.0 op_sel_hi:[1,0]
    v_pk_add_f32 v[220:221], v[220:221], 1.0 op_sel_hi:[1,0]
    v_pk_add_f32 v[222:223], v[222:223], 1.0 op_sel_hi:[1,0]
    v_pk_add_f32 v[224:225], v[224:225], 1.0 op_sel_hi:[1,0]
    v_pk_mul_f32 v[48:49], v[48:49], v[240:241] op_sel_hi:[1,0]
    v_pk_mul_f32 v[50:51], v[50:51], v[240:241] op_sel_hi:[1,0]
    v_pk_mul_f32 v[56:57], v[56:57], v[240:241] op_sel_hi:[1,0]
    v_pk_mul_f32 v[58:59], v[58:59], v[240:241] op_sel_hi:[1,0]
    v_rcp_f32 v218, v218
    v_rcp_f32 v219, v219
    v_rcp_f32 v220, v220
    v_rcp_f32 v221, v221
    v_rcp_f32 v222, v222
    v_rcp_f32 v223, v223
    v_rcp_f32 v224, v224
    v_rcp_f32 v225, v225
    s_nop 0
    v_pk_mul_f32 v[48:49], v[48:49], v[218:219]
    v_pk_mul_f32 v[50:51], v[50:51], v[220:221]
    v_pk_mul_f32 v[56:57], v[56:57], v[222:223]
    v_pk_mul_f32 v[58:59], v[58:59], v[224:225]
    v_cvt_pk_bf16_f32 v230, v48, v49
    v_cvt_pk_bf16_f32 v231, v50, v51
    v_cvt_pk_bf16_f32 v232, v56, v57
    v_cvt_pk_bf16_f32 v233, v58, v59
    s_add_u32 s28, s62, 98304
    s_nop 0
    buffer_store_dwordx4 v[230:233], v216, s[36:39], s28 offen sc1
    v_pk_fma_f32 v[64:65], v[160:161], v[200:201], v[64:65] op_sel_hi:[0,1,1]
    v_pk_fma_f32 v[66:67], v[160:161], v[202:203], v[66:67] op_sel_hi:[0,1,1]
    v_pk_fma_f32 v[72:73], v[160:161], v[208:209], v[72:73] op_sel_hi:[0,1,1]
    v_pk_fma_f32 v[74:75], v[160:161], v[210:211], v[74:75] op_sel_hi:[0,1,1]
    v_pk_mul_f32 v[218:219], v[64:65], v[234:235] op_sel_hi:[1,0]
    v_pk_mul_f32 v[220:221], v[66:67], v[234:235] op_sel_hi:[1,0]
    v_pk_mul_f32 v[222:223], v[72:73], v[234:235] op_sel_hi:[1,0]
    v_pk_mul_f32 v[224:225], v[74:75], v[234:235] op_sel_hi:[1,0]
    v_pk_fma_f32 v[68:69], v[160:161], v[204:205], v[68:69] op_sel_hi:[0,1,1]
    v_pk_fma_f32 v[70:71], v[160:161], v[206:207], v[70:71] op_sel_hi:[0,1,1]
    v_pk_fma_f32 v[76:77], v[160:161], v[212:213], v[76:77] op_sel_hi:[0,1,1]
    v_pk_fma_f32 v[78:79], v[160:161], v[214:215], v[78:79] op_sel_hi:[0,1,1]
    v_exp_f32 v218, v218
    v_exp_f32 v219, v219
    v_exp_f32 v220, v220
    v_exp_f32 v221, v221
    v_exp_f32 v222, v222
    v_exp_f32 v223, v223
    v_exp_f32 v224, v224
    v_exp_f32 v225, v225
    v_pk_mul_f32 v[64:65], v[64:65], v[68:69]
    v_pk_mul_f32 v[66:67], v[66:67], v[70:71]
    v_pk_mul_f32 v[72:73], v[72:73], v[76:77]
    v_pk_mul_f32 v[74:75], v[74:75], v[78:79]
    v_pk_add_f32 v[218:219], v[218:219], 1.0 op_sel_hi:[1,0]
    v_pk_add_f32 v[220:221], v[220:221], 1.0 op_sel_hi:[1,0]
    v_pk_add_f32 v[222:223], v[222:223], 1.0 op_sel_hi:[1,0]
    v_pk_add_f32 v[224:225], v[224:225], 1.0 op_sel_hi:[1,0]
    v_pk_mul_f32 v[64:65], v[64:65], v[236:237] op_sel_hi:[1,0]
    v_pk_mul_f32 v[66:67], v[66:67], v[236:237] op_sel_hi:[1,0]
    v_pk_mul_f32 v[72:73], v[72:73], v[236:237] op_sel_hi:[1,0]
    v_pk_mul_f32 v[74:75], v[74:75], v[236:237] op_sel_hi:[1,0]
    v_rcp_f32 v218, v218
    v_rcp_f32 v219, v219
    v_rcp_f32 v220, v220
    v_rcp_f32 v221, v221
    v_rcp_f32 v222, v222
    v_rcp_f32 v223, v223
    v_rcp_f32 v224, v224
    v_rcp_f32 v225, v225
    s_nop 0
    v_pk_mul_f32 v[64:65], v[64:65], v[218:219]
    v_pk_mul_f32 v[66:67], v[66:67], v[220:221]
    v_pk_mul_f32 v[72:73], v[72:73], v[222:223]
    v_pk_mul_f32 v[74:75], v[74:75], v[224:225]
    v_cvt_pk_bf16_f32 v226, v64, v65
    v_cvt_pk_bf16_f32 v227, v66, v67
    v_cvt_pk_bf16_f32 v228, v72, v73
    v_cvt_pk_bf16_f32 v229, v74, v75
    s_add_u32 s28, s63, 0
    s_nop 0
    buffer_store_dwordx4 v[226:229], v216, s[36:39], s28 offen sc1
    v_pk_fma_f32 v[80:81], v[162:163], v[200:201], v[80:81] op_sel_hi:[0,1,1]
    v_pk_fma_f32 v[82:83], v[162:163], v[202:203], v[82:83] op_sel_hi:[0,1,1]
    v_pk_fma_f32 v[88:89], v[162:163], v[208:209], v[88:89] op_sel_hi:[0,1,1]
    v_pk_fma_f32 v[90:91], v[162:163], v[210:211], v[90:91] op_sel_hi:[0,1,1]
    v_pk_mul_f32 v[218:219], v[80:81], v[238:239] op_sel_hi:[1,0]
    v_pk_mul_f32 v[220:221], v[82:83], v[238:239] op_sel_hi:[1,0]
    v_pk_mul_f32 v[222:223], v[88:89], v[238:239] op_sel_hi:[1,0]
    v_pk_mul_f32 v[224:225], v[90:91], v[238:239] op_sel_hi:[1,0]
    v_pk_fma_f32 v[84:85], v[162:163], v[204:205], v[84:85] op_sel_hi:[0,1,1]
    v_pk_fma_f32 v[86:87], v[162:163], v[206:207], v[86:87] op_sel_hi:[0,1,1]
    v_pk_fma_f32 v[92:93], v[162:163], v[212:213], v[92:93] op_sel_hi:[0,1,1]
    v_pk_fma_f32 v[94:95], v[162:163], v[214:215], v[94:95] op_sel_hi:[0,1,1]
    v_exp_f32 v218, v218
    v_exp_f32 v219, v219
    v_exp_f32 v220, v220
    v_exp_f32 v221, v221
    v_exp_f32 v222, v222
    v_exp_f32 v223, v223
    v_exp_f32 v224, v224
    v_exp_f32 v225, v225
    v_pk_mul_f32 v[80:81], v[80:81], v[84:85]
    v_pk_mul_f32 v[82:83], v[82:83], v[86:87]
    v_pk_mul_f32 v[88:89], v[88:89], v[92:93]
    v_pk_mul_f32 v[90:91], v[90:91], v[94:95]
    v_pk_add_f32 v[218:219], v[218:219], 1.0 op_sel_hi:[1,0]
    v_pk_add_f32 v[220:221], v[220:221], 1.0 op_sel_hi:[1,0]
    v_pk_add_f32 v[222:223], v[222:223], 1.0 op_sel_hi:[1,0]
    v_pk_add_f32 v[224:225], v[224:225], 1.0 op_sel_hi:[1,0]
    v_pk_mul_f32 v[80:81], v[80:81], v[240:241] op_sel_hi:[1,0]
    v_pk_mul_f32 v[82:83], v[82:83], v[240:241] op_sel_hi:[1,0]
    v_pk_mul_f32 v[88:89], v[88:89], v[240:241] op_sel_hi:[1,0]
    v_pk_mul_f32 v[90:91], v[90:91], v[240:241] op_sel_hi:[1,0]
    v_rcp_f32 v218, v218
    v_rcp_f32 v219, v219
    v_rcp_f32 v220, v220
    v_rcp_f32 v221, v221
    v_rcp_f32 v222, v222
    v_rcp_f32 v223, v223
    v_rcp_f32 v224, v224
    v_rcp_f32 v225, v225
    s_nop 0
    v_pk_mul_f32 v[80:81], v[80:81], v[218:219]
    v_pk_mul_f32 v[82:83], v[82:83], v[220:221]
    v_pk_mul_f32 v[88:89], v[88:89], v[222:223]
    v_pk_mul_f32 v[90:91], v[90:91], v[224:225]
    v_cvt_pk_bf16_f32 v230, v80, v81
    v_cvt_pk_bf16_f32 v231, v82, v83
    v_cvt_pk_bf16_f32 v232, v88, v89
    v_cvt_pk_bf16_f32 v233, v90, v91
    s_add_u32 s28, s63, 98304
    s_nop 0
    buffer_store_dwordx4 v[230:233], v216, s[36:39], s28 offen sc1
    v_mov_b32 v150, 154372
    v_mov_b32 v151, 1
    s_mov_b64 s[58:59], exec
    s_mov_b64 exec, 1
    ds_add_u32 v150, v151
    s_mov_b64 exec, s[58:59]
    s_waitcnt vmcnt(0)
    v_mov_b32 v150, 154368
    v_mov_b32 v151, 1
    s_mov_b64 s[58:59], exec
    s_mov_b64 exec, 1
    ds_add_rtn_u32 v152, v150, v151
    s_waitcnt lgkmcnt(0)
    v_readfirstlane_b32 s28, v152
    s_nop 3
    s_cmp_eq_u32 s28, 3
    s_cbranch_scc0 Lnopubh
    s_lshl_b32 s28, s22, 4
    s_add_u32 s28, s28, s23
    s_lshl_b32 s28, s28, 7
    s_add_u32 s28, s28, 13787136
    v_mov_b32 v150, 0
    buffer_store_dword v151, v150, s[36:39], s28 offen sc1
Lnopubh:
    s_mov_b64 exec, s[58:59]
    s_lshr_b32 s49, s20, 1
    s_lshl_b32 s49, s49, 3
    s_and_b32 s28, s21, 7
    s_add_u32 s49, s49, s28
    v_mov_b32 v231, v149
    v_lshlrev_b32 v228, 4, v149
    v_add_u32 v229, 4096, v228
    v_add_u32 v230, 8192, v228
    s_mul_i32 s26, s25, 12
    s_mul_i32 s27, s3, 5
    s_add_u32 s27, s27, 0
    s_mul_i32 s27, s27, 48
    s_add_u32 s27, s27, s26
    s_lshl_b32 s27, s27, 10
    s_add_u32 s44, s27, 11534336
    s_mul_i32 s27, s3, 5
    s_add_u32 s27, s27, 1
    s_mul_i32 s27, s27, 48
    s_add_u32 s27, s27, s26
    s_lshl_b32 s27, s27, 10
    s_add_u32 s45, s27, 11534336
    s_mul_i32 s27, s3, 5
    s_add_u32 s27, s27, 2
    s_mul_i32 s27, s27, 48
    s_add_u32 s27, s27, s26
    s_lshl_b32 s27, s27, 10
    s_add_u32 s46, s27, 11534336
    s_mul_i32 s27, s3, 5
    s_add_u32 s27, s27, 3
    s_mul_i32 s27, s27, 48
    s_add_u32 s27, s27, s26
    s_lshl_b32 s27, s27, 10
    s_add_u32 s47, s27, 11534336
    s_mul_i32 s27, s3, 5
    s_add_u32 s27, s27, 4
    s_mul_i32 s27, s27, 48
    s_add_u32 s27, s27, s26
    s_lshl_b32 s27, s27, 10
    s_add_u32 s48, s27, 11534336
    buffer_load_dwordx4 v[80:83], v229, s[36:39], s44 offen offset:0 sc1
    buffer_load_dwordx4 v[84:87], v229, s[36:39], s45 offen offset:0 sc1
    buffer_load_dwordx4 v[88:91], v229, s[36:39], s46 offen offset:0 sc1
    buffer_load_dwordx4 v[92:95], v229, s[36:39], s47 offen offset:0 sc1
    buffer_load_dwordx4 v[96:99], v229, s[36:39], s48 offen offset:0 sc1
    buffer_load_dwordx4 v[100:103], v229, s[36:39], s44 offen offset:1024 sc1
    buffer_load_dwordx4 v[104:107], v229, s[36:39], s45 offen offset:1024 sc1
    buffer_load_dwordx4 v[108:111], v229, s[36:39], s46 offen offset:1024 sc1
    buffer_load_dwordx4 v[112:115], v229, s[36:39], s47 offen offset:1024 sc1
    buffer_load_dwordx4 v[116:119], v229, s[36:39], s48 offen offset:1024 sc1
    buffer_load_dwordx4 v[120:123], v229, s[36:39], s44 offen offset:2048 sc1
    buffer_load_dwordx4 v[124:127], v229, s[36:39], s45 offen offset:2048 sc1
    buffer_load_dwordx4 v[128:131], v229, s[36:39], s46 offen offset:2048 sc1
    buffer_load_dwordx4 v[132:135], v229, s[36:39], s47 offen offset:2048 sc1
    buffer_load_dwordx4 v[136:139], v229, s[36:39], s48 offen offset:2048 sc1
    buffer_load_dwordx4 v[140:143], v229, s[36:39], s44 offen offset:3072 sc1
    buffer_load_dwordx4 v[144:147], v229, s[36:39], s45 offen offset:3072 sc1
    buffer_load_dwordx4 v[148:151], v229, s[36:39], s46 offen offset:3072 sc1
    buffer_load_dwordx4 v[152:155], v229, s[36:39], s47 offen offset:3072 sc1
    buffer_load_dwordx4 v[156:159], v229, s[36:39], s48 offen offset:3072 sc1
    s_mul_i32 s27, s25, 20480
    s_add_u32 s27, s27, 40960
    v_add_u32 v232, s27, v228
    s_lshl_b32 s27, s49, 2
    s_add_u32 s27, s27, 0
    s_mul_i32 s27, s27, 48
    s_add_u32 s27, s27, s26
    s_lshl_b32 s27, s27, 10
    s_add_u32 s30, s27, 0
    s_lshl_b32 s27, s49, 2
    s_add_u32 s27, s27, 1
    s_mul_i32 s27, s27, 48
    s_add_u32 s27, s27, s26
    s_lshl_b32 s27, s27, 10
    s_add_u32 s31, s27, 0
    s_lshl_b32 s27, s49, 2
    s_add_u32 s27, s27, 2
    s_mul_i32 s27, s27, 48
    s_add_u32 s27, s27, s26
    s_lshl_b32 s27, s27, 10
    s_add_u32 s32, s27, 0
    s_lshl_b32 s27, s49, 2
    s_add_u32 s27, s27, 3
    s_mul_i32 s27, s27, 48
    s_add_u32 s27, s27, s26
    s_lshl_b32 s27, s27, 10
    s_add_u32 s33, s27, 0
    s_waitcnt vmcnt(15)
    ds_write_b128 v232, v[80:83] offset:0
    ds_write_b128 v232, v[84:87] offset:1024
    ds_write_b128 v232, v[88:91] offset:2048
    ds_write_b128 v232, v[92:95] offset:3072
    ds_write_b128 v232, v[96:99] offset:4096
    s_waitcnt vmcnt(10)
    ds_write_b128 v232, v[100:103] offset:5120
    ds_write_b128 v232, v[104:107] offset:6144
    ds_write_b128 v232, v[108:111] offset:7168
    ds_write_b128 v232, v[112:115] offset:8192
    ds_write_b128 v232, v[116:119] offset:9216
    s_waitcnt vmcnt(5)
    ds_write_b128 v232, v[120:123] offset:10240
    ds_write_b128 v232, v[124:127] offset:11264
    ds_write_b128 v232, v[128:131] offset:12288
    ds_write_b128 v232, v[132:135] offset:13312
    ds_write_b128 v232, v[136:139] offset:14336
    s_waitcnt vmcnt(0)
    ds_write_b128 v232, v[140:143] offset:15360
    ds_write_b128 v232, v[144:147] offset:16384
    ds_write_b128 v232, v[148:151] offset:17408
    ds_write_b128 v232, v[152:155] offset:18432
    ds_write_b128 v232, v[156:159] offset:19456
    s_waitcnt lgkmcnt(0)
    buffer_load_dwordx4 v[80:83], v228, s[36:39], s44 offen offset:0 sc1
    buffer_load_dwordx4 v[84:87], v228, s[36:39], s45 offen offset:0 sc1
    buffer_load_dwordx4 v[88:91], v228, s[36:39], s46 offen offset:0 sc1
    buffer_load_dwordx4 v[92:95], v228, s[36:39], s47 offen offset:0 sc1
    buffer_load_dwordx4 v[96:99], v228, s[36:39], s48 offen offset:0 sc1
    buffer_load_dwordx4 v[100:103], v228, s[36:39], s44 offen offset:1024 sc1
    buffer_load_dwordx4 v[104:107], v228, s[36:39], s45 offen offset:1024 sc1
    buffer_load_dwordx4 v[108:111], v228, s[36:39], s46 offen offset:1024 sc1
    buffer_load_dwordx4 v[112:115], v228, s[36:39], s47 offen offset:1024 sc1
    buffer_load_dwordx4 v[116:119], v228, s[36:39], s48 offen offset:1024 sc1
    buffer_load_dwordx4 v[120:123], v228, s[36:39], s44 offen offset:2048 sc1
    buffer_load_dwordx4 v[124:127], v228, s[36:39], s45 offen offset:2048 sc1
    buffer_load_dwordx4 v[128:131], v228, s[36:39], s46 offen offset:2048 sc1
    buffer_load_dwordx4 v[132:135], v228, s[36:39], s47 offen offset:2048 sc1
    buffer_load_dwordx4 v[136:139], v228, s[36:39], s48 offen offset:2048 sc1
    buffer_load_dwordx4 v[140:143], v228, s[36:39], s44 offen offset:3072 sc1
    buffer_load_dwordx4 v[144:147], v228, s[36:39], s45 offen offset:3072 sc1
    buffer_load_dwordx4 v[148:151], v228, s[36:39], s46 offen offset:3072 sc1
    buffer_load_dwordx4 v[152:155], v228, s[36:39], s47 offen offset:3072 sc1
    buffer_load_dwordx4 v[156:159], v228, s[36:39], s48 offen offset:3072 sc1
    v_mov_b32 v0, 0
    v_mov_b32 v1, 0
    v_mov_b32 v2, 0
    v_mov_b32 v3, 0
    v_mov_b32 v4, 0
    v_mov_b32 v5, 0
    v_mov_b32 v6, 0
    v_mov_b32 v7, 0
    v_mov_b32 v8, 0
    v_mov_b32 v9, 0
    v_mov_b32 v10, 0
    v_mov_b32 v11, 0
    v_mov_b32 v12, 0
    v_mov_b32 v13, 0
    v_mov_b32 v14, 0
    v_mov_b32 v15, 0
    v_mov_b32 v16, 0
    v_mov_b32 v17, 0
    v_mov_b32 v18, 0
    v_mov_b32 v19, 0
    v_mov_b32 v20, 0
    v_mov_b32 v21, 0
    v_mov_b32 v22, 0
    v_mov_b32 v23, 0
    v_mov_b32 v24, 0
    v_mov_b32 v25, 0
    v_mov_b32 v26, 0
    v_mov_b32 v27, 0
    v_mov_b32 v28, 0
    v_mov_b32 v29, 0
    v_mov_b32 v30, 0
    v_mov_b32 v31, 0
    v_mov_b32 v32, 0
    v_mov_b32 v33, 0
    v_mov_b32 v34, 0
    v_mov_b32 v35, 0
    v_mov_b32 v36, 0
    v_mov_b32 v37, 0
    v_mov_b32 v38, 0
    v_mov_b32 v39, 0
    v_mov_b32 v40, 0
    v_mov_b32 v41, 0
    v_mov_b32 v42, 0
    v_mov_b32 v43, 0
    v_mov_b32 v44, 0
    v_mov_b32 v45, 0
    v_mov_b32 v46, 0
    v_mov_b32 v47, 0
    v_mov_b32 v48, 0
    v_mov_b32 v49, 0
    v_mov_b32 v50, 0
    v_mov_b32 v51, 0
    v_mov_b32 v52, 0
    v_mov_b32 v53, 0
    v_mov_b32 v54, 0
    v_mov_b32 v55, 0
    v_mov_b32 v56, 0
    v_mov_b32 v57, 0
    v_mov_b32 v58, 0
    v_mov_b32 v59, 0
    v_mov_b32 v60, 0
    v_mov_b32 v61, 0
    v_mov_b32 v62, 0
    v_mov_b32 v63, 0
    v_mov_b32 v64, 0
    v_mov_b32 v65, 0
    v_mov_b32 v66, 0
    v_mov_b32 v67, 0
    v_mov_b32 v68, 0
    v_mov_b32 v69, 0
    v_mov_b32 v70, 0
    v_mov_b32 v71, 0
    v_mov_b32 v72, 0
    v_mov_b32 v73, 0
    v_mov_b32 v74, 0
    v_mov_b32 v75, 0
    v_mov_b32 v76, 0
    v_mov_b32 v77, 0
    v_mov_b32 v78, 0
    v_mov_b32 v79, 0
    v_and_b32 v233, 3, v231
    v_lshlrev_b32 v233, 7, v233
    s_lshr_b32 s27, s49, 1
    s_lshl_b32 s27, s27, 11
    s_lshl_b32 s28, s25, 9
    s_add_u32 s27, s27, s28
    s_add_u32 s50, s27, 13787136
    buffer_load_dword v234, v233, s[36:39], s50 offen sc1
    s_waitcnt vmcnt(0)
    s_mov_b32 s82, 0
Lsph:
    v_cmp_eq_u32 vcc, 1, v234
    s_nop 1
    s_cmp_eq_u64 vcc, exec
    s_cbranch_scc1 Lspokh
    s_add_u32 s82, s82, 1
    s_cmp_gt_u32 s82, 1048576
    s_cbranch_scc1 Lmain_end
    s_sleep 1
    buffer_load_dword v234, v233, s[36:39], s50 offen sc1
    s_waitcnt vmcnt(0)
    s_branch Lsph
Lspokh:
    buffer_load_dwordx4 v[160:163], v228, s[36:39], s30 offen offset:0 sc1
    buffer_load_dwordx4 v[164:167], v228, s[36:39], s31 offen offset:0 sc1
    buffer_load_dwordx4 v[168:171], v228, s[36:39], s32 offen offset:0 sc1
    buffer_load_dwordx4 v[172:175], v228, s[36:39], s33 offen offset:0 sc1
    buffer_load_dwordx4 v[176:179], v228, s[36:39], s30 offen offset:1024 sc1
    buffer_load_dwordx4 v[180:183], v228, s[36:39], s31 offen offset:1024 sc1
    buffer_load_dwordx4 v[184:187], v228, s[36:39], s32 offen offset:1024 sc1
    buffer_load_dwordx4 v[188:191], v228, s[36:39], s33 offen offset:1024 sc1
    buffer_load_dwordx4 v[192:195], v228, s[36:39], s30 offen offset:2048 sc1
    buffer_load_dwordx4 v[196:199], v228, s[36:39], s31 offen offset:2048 sc1
    buffer_load_dwordx4 v[200:203], v228, s[36:39], s32 offen offset:2048 sc1
    buffer_load_dwordx4 v[204:207], v228, s[36:39], s33 offen offset:2048 sc1
    v_and_b32 v235, 31, v231
    v_lshlrev_b32 v235, 7, v235
    s_lshl_b32 s41, s3, 12
    s_add_u32 s41, s41, 13721600
    v_and_b32 v243, 15, v231
    v_lshrrev_b32 v244, 4, v231
    v_mul_u32_u24 v243, 1280, v243
    v_mul_u32_u24 v244, 40, v244
    v_add_u32 v240, v243, v244
    s_lshl_b32 s27, s49, 6
    s_lshl_b32 s28, s25, 4
    s_add_u32 s27, s27, s28
    s_mul_i32 s27, s27, 1280
    s_mul_i32 s28, s3, 160
    s_add_u32 s40, s27, s28
    v_lshrrev_b32 v243, 3, v231
    v_and_b32 v244, 7, v231
    v_lshlrev_b32 v241, 12, v243
    v_lshl_add_u32 v241, v244, 4, v241
    v_mul_u32_u24 v242, 136, v243
    v_lshl_add_u32 v242, v244, 4, v242
    s_mul_i32 s27, s3, 327680
    s_lshl_b32 s28, s49, 7
    s_add_u32 s27, s27, s28
    s_lshl_b32 s28, s25, 15
    s_add_u32 s27, s27, s28
    s_add_u32 s42, s27, 8912896
    s_mul_i32 s28, s25, 1088
    s_add_u32 s43, s28, 143360
    v_add_u32 v242, s43, v242
    s_mov_b32 s51, 0
    s_waitcnt vmcnt(8)
    v_mfma_f32_16x16x32_bf16 v[0:3], v[80:83], v[160:163], v[0:3]
    v_mfma_f32_16x16x32_bf16 v[4:7], v[84:87], v[160:163], v[4:7]
    v_mfma_f32_16x16x32_bf16 v[8:11], v[88:91], v[160:163], v[8:11]
    v_mfma_f32_16x16x32_bf16 v[12:15], v[92:95], v[160:163], v[12:15]
    v_mfma_f32_16x16x32_bf16 v[16:19], v[96:99], v[160:163], v[16:19]
    buffer_load_dwordx4 v[160:163], v228, s[36:39], s30 offen offset:3072 sc1
    v_mfma_f32_16x16x32_bf16 v[20:23], v[80:83], v[164:167], v[20:23]
    v_mfma_f32_16x16x32_bf16 v[24:27], v[84:87], v[164:167], v[24:27]
    v_mfma_f32_16x16x32_bf16 v[28:31], v[88:91], v[164:167], v[28:31]
    v_mfma_f32_16x16x32_bf16 v[32:35], v[92:95], v[164:167], v[32:35]
    v_mfma_f32_16x16x32_bf16 v[36:39], v[96:99], v[164:167], v[36:39]
    buffer_load_dwordx4 v[164:167], v228, s[36:39], s31 offen offset:3072 sc1
    v_mfma_f32_16x16x32_bf16 v[40:43], v[80:83], v[168:171], v[40:43]
    v_mfma_f32_16x16x32_bf16 v[44:47], v[84:87], v[168:171], v[44:47]
    v_mfma_f32_16x16x32_bf16 v[48:51], v[88:91], v[168:171], v[48:51]
    v_mfma_f32_16x16x32_bf16 v[52:55], v[92:95], v[168:171], v[52:55]
    v_mfma_f32_16x16x32_bf16 v[56:59], v[96:99], v[168:171], v[56:59]
    buffer_load_dwordx4 v[168:171], v228, s[36:39], s32 offen offset:3072 sc1
    v_mfma_f32_16x16x32_bf16 v[60:63], v[80:83], v[172:175], v[60:63]
    v_mfma_f32_16x16x32_bf16 v[64:67], v[84:87], v[172:175], v[64:67]
    v_mfma_f32_16x16x32_bf16 v[68:71], v[88:91], v[172:175], v[68:71]
    v_mfma_f32_16x16x32_bf16 v[72:75], v[92:95], v[172:175], v[72:75]
    v_mfma_f32_16x16x32_bf16 v[76:79], v[96:99], v[172:175], v[76:79]
    buffer_load_dwordx4 v[172:175], v228, s[36:39], s33 offen offset:3072 sc1
    s_waitcnt vmcnt(8)
    v_mfma_f32_16x16x32_bf16 v[0:3], v[100:103], v[176:179], v[0:3]
    v_mfma_f32_16x16x32_bf16 v[4:7], v[104:107], v[176:179], v[4:7]
    v_mfma_f32_16x16x32_bf16 v[8:11], v[108:111], v[176:179], v[8:11]
    v_mfma_f32_16x16x32_bf16 v[12:15], v[112:115], v[176:179], v[12:15]
    v_mfma_f32_16x16x32_bf16 v[16:19], v[116:119], v[176:179], v[16:19]
    buffer_load_dwordx4 v[176:179], v229, s[36:39], s30 offen offset:0 sc1
    v_mfma_f32_16x16x32_bf16 v[20:23], v[100:103], v[180:183], v[20:23]
    v_mfma_f32_16x16x32_bf16 v[24:27], v[104:107], v[180:183], v[24:27]
    buffer_load_dwordx4 v[80:83], v230, s[36:39], s44 offen offset:0 sc1
    v_mfma_f32_16x16x32_bf16 v[28:31], v[108:111], v[180:183], v[28:31]
    v_mfma_f32_16x16x32_bf16 v[32:35], v[112:115], v[180:183], v[32:35]
    v_mfma_f32_16x16x32_bf16 v[36:39], v[116:119], v[180:183], v[36:39]
    buffer_load_dwordx4 v[180:183], v229, s[36:39], s31 offen offset:0 sc1
    v_mfma_f32_16x16x32_bf16 v[40:43], v[100:103], v[184:187], v[40:43]
    v_mfma_f32_16x16x32_bf16 v[44:47], v[104:107], v[184:187], v[44:47]
    buffer_load_dwordx4 v[84:87], v230, s[36:39], s45 offen offset:0 sc1
    v_mfma_f32_16x16x32_bf16 v[48:51], v[108:111], v[184:187], v[48:51]
    v_mfma_f32_16x16x32_bf16 v[52:55], v[112:115], v[184:187], v[52:55]
    v_mfma_f32_16x16x32_bf16 v[56:59], v[116:119], v[184:187], v[56:59]
    buffer_load_dwordx4 v[184:187], v229, s[36:39], s32 offen offset:0 sc1
    v_mfma_f32_16x16x32_bf16 v[60:63], v[100:103], v[188:191], v[60:63]
    v_mfma_f32_16x16x32_bf16 v[64:67], v[104:107], v[188:191], v[64:67]
    buffer_load_dwordx4 v[88:91], v230, s[36:39], s46 offen offset:0 sc1
    v_mfma_f32_16x16x32_bf16 v[68:71], v[108:111], v[188:191], v[68:71]
    v_mfma_f32_16x16x32_bf16 v[72:75], v[112:115], v[188:191], v[72:75]
    v_mfma_f32_16x16x32_bf16 v[76:79], v[116:119], v[188:191], v[76:79]
    buffer_load_dwordx4 v[188:191], v229, s[36:39], s33 offen offset:0 sc1
    s_waitcnt vmcnt(11)
    v_mfma_f32_16x16x32_bf16 v[0:3], v[120:123], v[192:195], v[0:3]
    v_mfma_f32_16x16x32_bf16 v[4:7], v[124:127], v[192:195], v[4:7]
    v_mfma_f32_16x16x32_bf16 v[8:11], v[128:131], v[192:195], v[8:11]
    v_mfma_f32_16x16x32_bf16 v[12:15], v[132:135], v[192:195], v[12:15]
    v_mfma_f32_16x16x32_bf16 v[16:19], v[136:139], v[192:195], v[16:19]
    buffer_load_dwordx4 v[192:195], v229, s[36:39], s30 offen offset:1024 sc1
    v_mfma_f32_16x16x32_bf16 v[20:23], v[120:123], v[196:199], v[20:23]
    v_mfma_f32_16x16x32_bf16 v[24:27], v[124:127], v[196:199], v[24:27]
    buffer_load_dwordx4 v[92:95], v230, s[36:39], s47 offen offset:0 sc1
    v_mfma_f32_16x16x32_bf16 v[28:31], v[128:131], v[196:199], v[28:31]
    v_mfma_f32_16x16x32_bf16 v[32:35], v[132:135], v[196:199], v[32:35]
    v_mfma_f32_16x16x32_bf16 v[36:39], v[136:139], v[196:199], v[36:39]
    buffer_load_dwordx4 v[196:199], v229, s[36:39], s31 offen offset:1024 sc1
    v_mfma_f32_16x16x32_bf16 v[40:43], v[120:123], v[200:203], v[40:43]
    v_mfma_f32_16x16x32_bf16 v[44:47], v[124:127], v[200:203], v[44:47]
    buffer_load_dwordx4 v[96:99], v230, s[36:39], s48 offen offset:0 sc1
    v_mfma_f32_16x16x32_bf16 v[48:51], v[128:131], v[200:203], v[48:51]
    v_mfma_f32_16x16x32_bf16 v[52:55], v[132:135], v[200:203], v[52:55]
    v_mfma_f32_16x16x32_bf16 v[56:59], v[136:139], v[200:203], v[56:59]
    buffer_load_dwordx4 v[200:203], v229, s[36:39], s32 offen offset:1024 sc1
    v_mfma_f32_16x16x32_bf16 v[60:63], v[120:123], v[204:207], v[60:63]
    v_mfma_f32_16x16x32_bf16 v[64:67], v[124:127], v[204:207], v[64:67]
    buffer_load_dwordx4 v[100:103], v230, s[36:39], s44 offen offset:1024 sc1
    v_mfma_f32_16x16x32_bf16 v[68:71], v[128:131], v[204:207], v[68:71]
    v_mfma_f32_16x16x32_bf16 v[72:75], v[132:135], v[204:207], v[72:75]
    v_mfma_f32_16x16x32_bf16 v[76:79], v[136:139], v[204:207], v[76:79]
    buffer_load_dwordx4 v[204:207], v229, s[36:39], s33 offen offset:1024 sc1
    s_waitcnt vmcnt(14)
    v_mfma_f32_16x16x32_bf16 v[0:3], v[140:143], v[160:163], v[0:3]
    v_mfma_f32_16x16x32_bf16 v[4:7], v[144:147], v[160:163], v[4:7]
    v_mfma_f32_16x16x32_bf16 v[8:11], v[148:151], v[160:163], v[8:11]
    v_mfma_f32_16x16x32_bf16 v[12:15], v[152:155], v[160:163], v[12:15]
    v_mfma_f32_16x16x32_bf16 v[16:19], v[156:159], v[160:163], v[16:19]
    buffer_load_dwordx4 v[160:163], v229, s[36:39], s30 offen offset:2048 sc1
    v_mfma_f32_16x16x32_bf16 v[20:23], v[140:143], v[164:167], v[20:23]
    v_mfma_f32_16x16x32_bf16 v[24:27], v[144:147], v[164:167], v[24:27]
    buffer_load_dwordx4 v[104:107], v230, s[36:39], s45 offen offset:1024 sc1
    v_mfma_f32_16x16x32_bf16 v[28:31], v[148:151], v[164:167], v[28:31]
    v_mfma_f32_16x16x32_bf16 v[32:35], v[152:155], v[164:167], v[32:35]
    v_mfma_f32_16x16x32_bf16 v[36:39], v[156:159], v[164:167], v[36:39]
    buffer_load_dwordx4 v[164:167], v229, s[36:39], s31 offen offset:2048 sc1
    v_mfma_f32_16x16x32_bf16 v[40:43], v[140:143], v[168:171], v[40:43]
    v_mfma_f32_16x16x32_bf16 v[44:47], v[144:147], v[168:171], v[44:47]
    buffer_load_dwordx4 v[108:111], v230, s[36:39], s46 offen offset:1024 sc1
    v_mfma_f32_16x16x32_bf16 v[48:51], v[148:151], v[168:171], v[48:51]
    v_mfma_f32_16x16x32_bf16 v[52:55], v[152:155], v[168:171], v[52:55]
    v_mfma_f32_16x16x32_bf16 v[56:59], v[156:159], v[168:171], v[56:59]
    buffer_load_dwordx4 v[168:171], v229, s[36:39], s32 offen offset:2048 sc1
    v_mfma_f32_16x16x32_bf16 v[60:63], v[140:143], v[172:175], v[60:63]
    ds_read_b128 v[208:211], v232 offset:0
    v_mfma_f32_16x16x32_bf16 v[64:67], v[144:147], v[172:175], v[64:67]
    ds_read_b128 v[212:215], v232 offset:1024
    buffer_load_dwordx4 v[112:115], v230, s[36:39], s47 offen offset:1024 sc1
    v_mfma_f32_16x16x32_bf16 v[68:71], v[148:151], v[172:175], v[68:71]
    ds_read_b128 v[216:219], v232 offset:2048
    v_mfma_f32_16x16x32_bf16 v[72:75], v[152:155], v[172:175], v[72:75]
    ds_read_b128 v[220:223], v232 offset:3072
    v_mfma_f32_16x16x32_bf16 v[76:79], v[156:159], v[172:175], v[76:79]
    ds_read_b128 v[224:227], v232 offset:4096
    buffer_load_dwordx4 v[172:175], v229, s[36:39], s33 offen offset:2048 sc1
    s_waitcnt vmcnt(14)
    s_waitcnt lgkmcnt(4)
    v_mfma_f32_16x16x32_bf16 v[0:3], v[208:211], v[176:179], v[0:3]
    v_mfma_f32_16x16x32_bf16 v[20:23], v[208:211], v[180:183], v[20:23]
    v_mfma_f32_16x16x32_bf16 v[40:43], v[208:211], v[184:187], v[40:43]
    v_mfma_f32_16x16x32_bf16 v[60:63], v[208:211], v[188:191], v[60:63]
    ds_read_b128 v[208:211], v232 offset:5120
    buffer_load_dwordx4 v[116:119], v230, s[36:39], s48 offen offset:1024 sc1
    s_waitcnt lgkmcnt(4)
    v_mfma_f32_16x16x32_bf16 v[4:7], v[212:215], v[176:179], v[4:7]
    v_mfma_f32_16x16x32_bf16 v[24:27], v[212:215], v[180:183], v[24:27]
    v_mfma_f32_16x16x32_bf16 v[44:47], v[212:215], v[184:187], v[44:47]
    v_mfma_f32_16x16x32_bf16 v[64:67], v[212:215], v[188:191], v[64:67]
    ds_read_b128 v[212:215], v232 offset:6144
    buffer_load_dwordx4 v[120:123], v230, s[36:39], s44 offen offset:2048 sc1
    s_waitcnt lgkmcnt(4)
    v_mfma_f32_16x16x32_bf16 v[8:11], v[216:219], v[176:179], v[8:11]
    v_mfma_f32_16x16x32_bf16 v[28:31], v[216:219], v[180:183], v[28:31]
    v_mfma_f32_16x16x32_bf16 v[48:51], v[216:219], v[184:187], v[48:51]
    v_mfma_f32_16x16x32_bf16 v[68:71], v[216:219], v[188:191], v[68:71]
    ds_read_b128 v[216:219], v232 offset:7168
    buffer_load_dwordx4 v[124:127], v230, s[36:39], s45 offen offset:2048 sc1
    s_waitcnt lgkmcnt(4)
    v_mfma_f32_16x16x32_bf16 v[12:15], v[220:223], v[176:179], v[12:15]
    v_mfma_f32_16x16x32_bf16 v[32:35], v[220:223], v[180:183], v[32:35]
    v_mfma_f32_16x16x32_bf16 v[52:55], v[220:223], v[184:187], v[52:55]
    v_mfma_f32_16x16x32_bf16 v[72:75], v[220:223], v[188:191], v[72:75]
    ds_read_b128 v[220:223], v232 offset:8192
    buffer_load_dwordx4 v[128:131], v230, s[36:39], s46 offen offset:2048 sc1
    s_waitcnt lgkmcnt(4)
    v_mfma_f32_16x16x32_bf16 v[16:19], v[224:227], v[176:179], v[16:19]
    v_mfma_f32_16x16x32_bf16 v[36:39], v[224:227], v[180:183], v[36:39]
    v_mfma_f32_16x16x32_bf16 v[56:59], v[224:227], v[184:187], v[56:59]
    v_mfma_f32_16x16x32_bf16 v[76:79], v[224:227], v[188:191], v[76:79]
    ds_read_b128 v[224:227], v232 offset:9216
    buffer_load_dwordx4 v[132:135], v230, s[36:39], s47 offen offset:2048 sc1
    s_waitcnt vmcnt(12)
    s_waitcnt lgkmcnt(4)
    v_mfma_f32_16x16x32_bf16 v[0:3], v[208:211], v[192:195], v[0:3]
    v_mfma_f32_16x16x32_bf16 v[20:23], v[208:211], v[196:199], v[20:23]
    v_mfma_f32_16x16x32_bf16 v[40:43], v[208:211], v[200:203], v[40:43]
    v_mfma_f32_16x16x32_bf16 v[60:63], v[208:211], v[204:207], v[60:63]
    ds_read_b128 v[208:211], v232 offset:10240
    buffer_load_dwordx4 v[176:179], v229, s[36:39], s30 offen offset:3072 sc1
    s_waitcnt lgkmcnt(4)
    v_mfma_f32_16x16x32_bf16 v[4:7], v[212:215], v[192:195], v[4:7]
    v_mfma_f32_16x16x32_bf16 v[24:27], v[212:215], v[196:199], v[24:27]
    v_mfma_f32_16x16x32_bf16 v[44:47], v[212:215], v[200:203], v[44:47]
    v_mfma_f32_16x16x32_bf16 v[64:67], v[212:215], v[204:207], v[64:67]
    ds_read_b128 v[212:215], v232 offset:11264
    buffer_load_dwordx4 v[180:183], v229, s[36:39], s31 offen offset:3072 sc1
    s_waitcnt lgkmcnt(4)
    v_mfma_f32_16x16x32_bf16 v[8:11], v[216:219], v[192:195], v[8:11]
    v_mfma_f32_16x16x32_bf16 v[28:31], v[216:219], v[196:199], v[28:31]
    v_mfma_f32_16x16x32_bf16 v[48:51], v[216:219], v[200:203], v[48:51]
    v_mfma_f32_16x16x32_bf16 v[68:71], v[216:219], v[204:207], v[68:71]
    ds_read_b128 v[216:219], v232 offset:12288
    buffer_load_dwordx4 v[184:187], v229, s[36:39], s32 offen offset:3072 sc1
    s_waitcnt lgkmcnt(4)
    v_mfma_f32_16x16x32_bf16 v[12:15], v[220:223], v[192:195], v[12:15]
    v_mfma_f32_16x16x32_bf16 v[32:35], v[220:223], v[196:199], v[32:35]
    v_mfma_f32_16x16x32_bf16 v[52:55], v[220:223], v[200:203], v[52:55]
    v_mfma_f32_16x16x32_bf16 v[72:75], v[220:223], v[204:207], v[72:75]
    ds_read_b128 v[220:223], v232 offset:13312
    buffer_load_dwordx4 v[188:191], v229, s[36:39], s33 offen offset:3072 sc1
    s_waitcnt lgkmcnt(4)
    v_mfma_f32_16x16x32_bf16 v[16:19], v[224:227], v[192:195], v[16:19]
    v_mfma_f32_16x16x32_bf16 v[36:39], v[224:227], v[196:199], v[36:39]
    v_mfma_f32_16x16x32_bf16 v[56:59], v[224:227], v[200:203], v[56:59]
    v_mfma_f32_16x16x32_bf16 v[76:79], v[224:227], v[204:207], v[76:79]
    ds_read_b128 v[224:227], v232 offset:14336
    buffer_load_dwordx4 v[136:139], v230, s[36:39], s48 offen offset:2048 sc1
    s_waitcnt vmcnt(10)
    s_waitcnt lgkmcnt(4)
    v_mfma_f32_16x16x32_bf16 v[0:3], v[208:211], v[160:163], v[0:3]
    v_mfma_f32_16x16x32_bf16 v[20:23], v[208:211], v[164:167], v[20:23]
    v_mfma_f32_16x16x32_bf16 v[40:43], v[208:211], v[168:171], v[40:43]
    v_mfma_f32_16x16x32_bf16 v[60:63], v[208:211], v[172:175], v[60:63]
    ds_read_b128 v[208:211], v232 offset:15360
    buffer_load_dwordx4 v[192:195], v230, s[36:39], s30 offen offset:0 sc1
    s_waitcnt lgkmcnt(4)
    v_mfma_f32_16x16x32_bf16 v[4:7], v[212:215], v[160:163], v[4:7]
    v_mfma_f32_16x16x32_bf16 v[24:27], v[212:215], v[164:167], v[24:27]
    v_mfma_f32_16x16x32_bf16 v[44:47], v[212:215], v[168:171], v[44:47]
    v_mfma_f32_16x16x32_bf16 v[64:67], v[212:215], v[172:175], v[64:67]
    ds_read_b128 v[212:215], v232 offset:16384
    buffer_load_dwordx4 v[196:199], v230, s[36:39], s31 offen offset:0 sc1
    s_waitcnt lgkmcnt(4)
    v_mfma_f32_16x16x32_bf16 v[8:11], v[216:219], v[160:163], v[8:11]
    v_mfma_f32_16x16x32_bf16 v[28:31], v[216:219], v[164:167], v[28:31]
    v_mfma_f32_16x16x32_bf16 v[48:51], v[216:219], v[168:171], v[48:51]
    v_mfma_f32_16x16x32_bf16 v[68:71], v[216:219], v[172:175], v[68:71]
    ds_read_b128 v[216:219], v232 offset:17408
    buffer_load_dwordx4 v[200:203], v230, s[36:39], s32 offen offset:0 sc1
    s_waitcnt lgkmcnt(4)
    v_mfma_f32_16x16x32_bf16 v[12:15], v[220:223], v[160:163], v[12:15]
    v_mfma_f32_16x16x32_bf16 v[32:35], v[220:223], v[164:167], v[32:35]
    v_mfma_f32_16x16x32_bf16 v[52:55], v[220:223], v[168:171], v[52:55]
    v_mfma_f32_16x16x32_bf16 v[72:75], v[220:223], v[172:175], v[72:75]
    ds_read_b128 v[220:223], v232 offset:18432
    buffer_load_dwordx4 v[204:207], v230, s[36:39], s33 offen offset:0 sc1
    s_waitcnt lgkmcnt(4)
    v_mfma_f32_16x16x32_bf16 v[16:19], v[224:227], v[160:163], v[16:19]
    v_mfma_f32_16x16x32_bf16 v[36:39], v[224:227], v[164:167], v[36:39]
    v_mfma_f32_16x16x32_bf16 v[56:59], v[224:227], v[168:171], v[56:59]
    v_mfma_f32_16x16x32_bf16 v[76:79], v[224:227], v[172:175], v[76:79]
    ds_read_b128 v[224:227], v232 offset:19456
    buffer_load_dwordx4 v[140:143], v230, s[36:39], s44 offen offset:3072 sc1
    s_waitcnt vmcnt(6)
    s_waitcnt lgkmcnt(4)
    v_mfma_f32_16x16x32_bf16 v[0:3], v[208:211], v[176:179], v[0:3]
    v_mfma_f32_16x16x32_bf16 v[20:23], v[208:211], v[180:183], v[20:23]
    v_mfma_f32_16x16x32_bf16 v[40:43], v[208:211], v[184:187], v[40:43]
    v_mfma_f32_16x16x32_bf16 v[60:63], v[208:211], v[188:191], v[60:63]
    buffer_load_dwordx4 v[160:163], v230, s[36:39], s30 offen offset:1024 sc1
    s_waitcnt lgkmcnt(3)
    v_mfma_f32_16x16x32_bf16 v[4:7], v[212:215], v[176:179], v[4:7]
    v_mfma_f32_16x16x32_bf16 v[24:27], v[212:215], v[180:183], v[24:27]
    v_mfma_f32_16x16x32_bf16 v[44:47], v[212:215], v[184:187], v[44:47]
    v_mfma_f32_16x16x32_bf16 v[64:67], v[212:215], v[188:191], v[64:67]
    buffer_load_dwordx4 v[164:167], v230, s[36:39], s31 offen offset:1024 sc1
    s_waitcnt lgkmcnt(2)
    v_mfma_f32_16x16x32_bf16 v[8:11], v[216:219], v[176:179], v[8:11]
    v_mfma_f32_16x16x32_bf16 v[28:31], v[216:219], v[180:183], v[28:31]
    v_mfma_f32_16x16x32_bf16 v[48:51], v[216:219], v[184:187], v[48:51]
    v_mfma_f32_16x16x32_bf16 v[68:71], v[216:219], v[188:191], v[68:71]
    buffer_load_dwordx4 v[168:171], v230, s[36:39], s32 offen offset:1024 sc1
    s_waitcnt lgkmcnt(1)
    v_mfma_f32_16x16x32_bf16 v[12:15], v[220:223], v[176:179], v[12:15]
    v_mfma_f32_16x16x32_bf16 v[32:35], v[220:223], v[180:183], v[32:35]
    v_mfma_f32_16x16x32_bf16 v[52:55], v[220:223], v[184:187], v[52:55]
    v_mfma_f32_16x16x32_bf16 v[72:75], v[220:223], v[188:191], v[72:75]
    buffer_load_dwordx4 v[172:175], v230, s[36:39], s33 offen offset:1024 sc1
    s_waitcnt lgkmcnt(0)
    v_mfma_f32_16x16x32_bf16 v[16:19], v[224:227], v[176:179], v[16:19]
    v_mfma_f32_16x16x32_bf16 v[36:39], v[224:227], v[180:183], v[36:39]
    v_mfma_f32_16x16x32_bf16 v[56:59], v[224:227], v[184:187], v[56:59]
    v_mfma_f32_16x16x32_bf16 v[76:79], v[224:227], v[188:191], v[76:79]
    buffer_load_dwordx4 v[144:147], v230, s[36:39], s45 offen offset:3072 sc1
    buffer_load_dwordx4 v[176:179], v230, s[36:39], s30 offen offset:2048 sc1
    buffer_load_dwordx4 v[180:183], v230, s[36:39], s31 offen offset:2048 sc1
    buffer_load_dwordx4 v[184:187], v230, s[36:39], s32 offen offset:2048 sc1
    buffer_load_dwordx4 v[188:191], v230, s[36:39], s33 offen offset:2048 sc1
    buffer_load_dwordx4 v[148:151], v230, s[36:39], s46 offen offset:3072 sc1
    buffer_load_dwordx4 v[152:155], v230, s[36:39], s47 offen offset:3072 sc1
    buffer_load_dwordx4 v[156:159], v230, s[36:39], s48 offen offset:3072 sc1
    s_waitcnt vmcnt(13)
    v_mfma_f32_16x16x32_bf16 v[0:3], v[80:83], v[192:195], v[0:3]
    v_mfma_f32_16x16x32_bf16 v[4:7], v[84:87], v[192:195], v[4:7]
    v_mfma_f32_16x16x32_bf16 v[8:11], v[88:91], v[192:195], v[8:11]
    v_mfma_f32_16x16x32_bf16 v[12:15], v[92:95], v[192:195], v[12:15]
    v_mfma_f32_16x16x32_bf16 v[16:19], v[96:99], v[192:195], v[16:19]
    buffer_load_dwordx4 v[192:195], v230, s[36:39], s30 offen offset:3072 sc1
    v_mfma_f32_16x16x32_bf16 v[20:23], v[80:83], v[196:199], v[20:23]
    v_mfma_f32_16x16x32_bf16 v[24:27], v[84:87], v[196:199], v[24:27]
    v_mfma_f32_16x16x32_bf16 v[28:31], v[88:91], v[196:199], v[28:31]
    v_mfma_f32_16x16x32_bf16 v[32:35], v[92:95], v[196:199], v[32:35]
    v_mfma_f32_16x16x32_bf16 v[36:39], v[96:99], v[196:199], v[36:39]
    buffer_load_dwordx4 v[196:199], v230, s[36:39], s31 offen offset:3072 sc1
    v_mfma_f32_16x16x32_bf16 v[40:43], v[80:83], v[200:203], v[40:43]
    v_mfma_f32_16x16x32_bf16 v[44:47], v[84:87], v[200:203], v[44:47]
    v_mfma_f32_16x16x32_bf16 v[48:51], v[88:91], v[200:203], v[48:51]
    v_mfma_f32_16x16x32_bf16 v[52:55], v[92:95], v[200:203], v[52:55]
    v_mfma_f32_16x16x32_bf16 v[56:59], v[96:99], v[200:203], v[56:59]
    buffer_load_dwordx4 v[200:203], v230, s[36:39], s32 offen offset:3072 sc1
    v_mfma_f32_16x16x32_bf16 v[60:63], v[80:83], v[204:207], v[60:63]
    v_mfma_f32_16x16x32_bf16 v[64:67], v[84:87], v[204:207], v[64:67]
    v_mfma_f32_16x16x32_bf16 v[68:71], v[88:91], v[204:207], v[68:71]
    v_mfma_f32_16x16x32_bf16 v[72:75], v[92:95], v[204:207], v[72:75]
    v_mfma_f32_16x16x32_bf16 v[76:79], v[96:99], v[204:207], v[76:79]
    buffer_load_dwordx4 v[204:207], v230, s[36:39], s33 offen offset:3072 sc1
    buffer_load_dwordx4 v[236:239], v235, s[36:39], s41 offen sc1
    buffer_load_dwordx4 v[208:211], v240, s[8:11], s40 offen
    buffer_load_dwordx4 v[212:215], v240, s[8:11], s40 offen offset:16
    buffer_load_dwordx2 v[216:217], v240, s[8:11], s40 offen offset:32
    s_waitcnt vmcnt(16)
    v_mfma_f32_16x16x32_bf16 v[0:3], v[100:103], v[160:163], v[0:3]
    v_mfma_f32_16x16x32_bf16 v[4:7], v[104:107], v[160:163], v[4:7]
    v_mfma_f32_16x16x32_bf16 v[8:11], v[108:111], v[160:163], v[8:11]
    v_mfma_f32_16x16x32_bf16 v[12:15], v[112:115], v[160:163], v[12:15]
    v_mfma_f32_16x16x32_bf16 v[16:19], v[116:119], v[160:163], v[16:19]
    v_mfma_f32_16x16x32_bf16 v[20:23], v[100:103], v[164:167], v[20:23]
    v_mfma_f32_16x16x32_bf16 v[24:27], v[104:107], v[164:167], v[24:27]
    v_mfma_f32_16x16x32_bf16 v[28:31], v[108:111], v[164:167], v[28:31]
    v_mfma_f32_16x16x32_bf16 v[32:35], v[112:115], v[164:167], v[32:35]
    v_mfma_f32_16x16x32_bf16 v[36:39], v[116:119], v[164:167], v[36:39]
    v_mfma_f32_16x16x32_bf16 v[40:43], v[100:103], v[168:171], v[40:43]
    v_mfma_f32_16x16x32_bf16 v[44:47], v[104:107], v[168:171], v[44:47]
    v_mfma_f32_16x16x32_bf16 v[48:51], v[108:111], v[168:171], v[48:51]
    v_mfma_f32_16x16x32_bf16 v[52:55], v[112:115], v[168:171], v[52:55]
    v_mfma_f32_16x16x32_bf16 v[56:59], v[116:119], v[168:171], v[56:59]
    v_mfma_f32_16x16x32_bf16 v[60:63], v[100:103], v[172:175], v[60:63]
    v_mfma_f32_16x16x32_bf16 v[64:67], v[104:107], v[172:175], v[64:67]
    v_mfma_f32_16x16x32_bf16 v[68:71], v[108:111], v[172:175], v[68:71]
    v_mfma_f32_16x16x32_bf16 v[72:75], v[112:115], v[172:175], v[72:75]
    v_mfma_f32_16x16x32_bf16 v[76:79], v[116:119], v[172:175], v[76:79]
    s_waitcnt vmcnt(11)
    v_mfma_f32_16x16x32_bf16 v[0:3], v[120:123], v[176:179], v[0:3]
    v_mfma_f32_16x16x32_bf16 v[4:7], v[124:127], v[176:179], v[4:7]
    v_mfma_f32_16x16x32_bf16 v[8:11], v[128:131], v[176:179], v[8:11]
    v_mfma_f32_16x16x32_bf16 v[12:15], v[132:135], v[176:179], v[12:15]
    v_mfma_f32_16x16x32_bf16 v[16:19], v[136:139], v[176:179], v[16:19]
    v_mfma_f32_16x16x32_bf16 v[20:23], v[120:123], v[180:183], v[20:23]
    v_mfma_f32_16x16x32_bf16 v[24:27], v[124:127], v[180:183], v[24:27]
    v_mfma_f32_16x16x32_bf16 v[28:31], v[128:131], v[180:183], v[28:31]
    v_mfma_f32_16x16x32_bf16 v[32:35], v[132:135], v[180:183], v[32:35]
    v_mfma_f32_16x16x32_bf16 v[36:39], v[136:139], v[180:183], v[36:39]
    v_mfma_f32_16x16x32_bf16 v[40:43], v[120:123], v[184:187], v[40:43]
    v_mfma_f32_16x16x32_bf16 v[44:47], v[124:127], v[184:187], v[44:47]
    v_mfma_f32_16x16x32_bf16 v[48:51], v[128:131], v[184:187], v[48:51]
    v_mfma_f32_16x16x32_bf16 v[52:55], v[132:135], v[184:187], v[52:55]
    v_mfma_f32_16x16x32_bf16 v[56:59], v[136:139], v[184:187], v[56:59]
    v_mfma_f32_16x16x32_bf16 v[60:63], v[120:123], v[188:191], v[60:63]
    v_mfma_f32_16x16x32_bf16 v[64:67], v[124:127], v[188:191], v[64:67]
    v_mfma_f32_16x16x32_bf16 v[68:71], v[128:131], v[188:191], v[68:71]
    v_mfma_f32_16x16x32_bf16 v[72:75], v[132:135], v[188:191], v[72:75]
    v_mfma_f32_16x16x32_bf16 v[76:79], v[136:139], v[188:191], v[76:79]
    s_waitcnt vmcnt(3)
    v_and_b32 v236, v236, v237
    v_and_b32 v236, v236, v238
    v_cmp_eq_u32 vcc, 1, v236
    s_nop 1
    s_cmp_eq_u64 vcc, exec
    s_cbranch_scc0 Lnotyet
    s_mov_b32 s51, 1
    s_add_u32 s27, s42, 0
    buffer_load_dwordx4 v[80:83], v241, s[36:39], s27 offen sc1
    s_add_u32 s27, s42, 131072
    buffer_load_dwordx4 v[84:87], v241, s[36:39], s27 offen sc1
    s_cmp_lt_u32 s25, 2
    s_cbranch_scc0 Lnoate
    s_add_u32 s27, s42, 262144
    buffer_load_dwordx4 v[88:91], v241, s[36:39], s27 offen sc1
Lnoate:
Lnotyet:
    v_mfma_f32_16x16x32_bf16 v[0:3], v[140:143], v[192:195], v[0:3]
    v_mfma_f32_16x16x32_bf16 v[4:7], v[144:147], v[192:195], v[4:7]
    v_mfma_f32_16x16x32_bf16 v[8:11], v[148:151], v[192:195], v[8:11]
    v_mfma_f32_16x16x32_bf16 v[12:15], v[152:155], v[192:195], v[12:15]
    v_mfma_f32_16x16x32_bf16 v[16:19], v[156:159], v[192:195], v[16:19]
    v_mfma_f32_16x16x32_bf16 v[20:23], v[140:143], v[196:199], v[20:23]
    v_mfma_f32_16x16x32_bf16 v[24:27], v[144:147], v[196:199], v[24:27]
    v_mfma_f32_16x16x32_bf16 v[28:31], v[148:151], v[196:199], v[28:31]
    v_mfma_f32_16x16x32_bf16 v[32:35], v[152:155], v[196:199], v[32:35]
    v_mfma_f32_16x16x32_bf16 v[36:39], v[156:159], v[196:199], v[36:39]
    v_mfma_f32_16x16x32_bf16 v[40:43], v[140:143], v[200:203], v[40:43]
    v_mfma_f32_16x16x32_bf16 v[44:47], v[144:147], v[200:203], v[44:47]
    v_mfma_f32_16x16x32_bf16 v[48:51], v[148:151], v[200:203], v[48:51]
    v_mfma_f32_16x16x32_bf16 v[52:55], v[152:155], v[200:203], v[52:55]
    v_mfma_f32_16x16x32_bf16 v[56:59], v[156:159], v[200:203], v[56:59]
    v_mfma_f32_16x16x32_bf16 v[60:63], v[140:143], v[204:207], v[60:63]
    v_mfma_f32_16x16x32_bf16 v[64:67], v[144:147], v[204:207], v[64:67]
    v_mfma_f32_16x16x32_bf16 v[68:71], v[148:151], v[204:207], v[68:71]
    v_mfma_f32_16x16x32_bf16 v[72:75], v[152:155], v[204:207], v[72:75]
    v_mfma_f32_16x16x32_bf16 v[76:79], v[156:159], v[204:207], v[76:79]
    s_cmp_eq_u32 s51, 1
    s_cbranch_scc1 Lhave
    buffer_load_dwordx4 v[236:239], v235, s[36:39], s41 offen sc1
    s_waitcnt vmcnt(0)
    s_mov_b32 s82, 0
Lspd:
    v_and_b32 v236, v236, v237
    v_and_b32 v236, v236, v238
    v_cmp_eq_u32 vcc, 1, v236
    s_nop 1
    s_cmp_eq_u64 vcc, exec
    s_cbranch_scc1 Lspokd
    s_add_u32 s82, s82, 1
    s_cmp_gt_u32 s82, 1048576
    s_cbranch_scc1 Lmain_end
    s_sleep 1
    buffer_load_dwordx4 v[236:239], v235, s[36:39], s41 offen sc1
    s_waitcnt vmcnt(0)
    s_branch Lspd
Lspokd:
    s_add_u32 s27, s42, 0
    buffer_load_dwordx4 v[80:83], v241, s[36:39], s27 offen sc1
    s_add_u32 s27, s42, 131072
    buffer_load_dwordx4 v[84:87], v241, s[36:39], s27 offen sc1
    s_cmp_lt_u32 s25, 2
    s_cbranch_scc0 Lnoatl
    s_add_u32 s27, s42, 262144
    buffer_load_dwordx4 v[88:91], v241, s[36:39], s27 offen sc1
Lnoatl:
Lhave:
    v_add_u32 v229, 40960, v228
    v_add_u32 v230, 90112, v228
    s_cmp_lg_u32 s25, 0
    s_cbranch_scc1 Lw_1
    ds_write_b128 v229, v[20:23] offset:0
    ds_write_b128 v229, v[24:27] offset:1024
    ds_write_b128 v229, v[28:31] offset:2048
    ds_write_b128 v229, v[32:35] offset:3072
    ds_write_b128 v229, v[36:39] offset:4096
    ds_write_b128 v229, v[40:43] offset:5120
    ds_write_b128 v229, v[44:47] offset:6144
    ds_write_b128 v229, v[48:51] offset:7168
    ds_write_b128 v229, v[52:55] offset:8192
    ds_write_b128 v229, v[56:59] offset:9216
    ds_write_b128 v229, v[60:63] offset:10240
    ds_write_b128 v229, v[64:67] offset:11264
    ds_write_b128 v229, v[68:71] offset:12288
    ds_write_b128 v229, v[72:75] offset:13312
    ds_write_b128 v229, v[76:79] offset:14336
    s_waitcnt vmcnt(0)
    ds_write_b64 v242, v[80:81] offset:0
    ds_write_b64 v242, v[82:83] offset:8
    ds_write_b64 v242, v[84:85] offset:4352
    ds_write_b64 v242, v[86:87] offset:4360
    ds_write_b64 v242, v[88:89] offset:8704
    ds_write_b64 v242, v[90:91] offset:8712
    s_waitcnt lgkmcnt(0)
    s_barrier
    ds_read_b128 v[96:99], v229 offset:20480
    ds_read_b128 v[100:103], v229 offset:21504
    ds_read_b128 v[104:107], v229 offset:22528
    ds_read_b128 v[108:111], v229 offset:23552
    ds_read_b128 v[112:115], v229 offset:24576
    ds_read_b128 v[116:119], v229 offset:40960
    ds_read_b128 v[120:123], v229 offset:41984
    ds_read_b128 v[124:127], v229 offset:43008
    ds_read_b128 v[128:131], v229 offset:44032
    ds_read_b128 v[132:135], v229 offset:45056
    ds_read_b128 v[136:139], v229 offset:61440
    ds_read_b128 v[140:143], v229 offset:62464
    ds_read_b128 v[144:147], v229 offset:63488
    ds_read_b128 v[148:151], v230 offset:15360
    ds_read_b128 v[152:155], v230 offset:16384
    s_branch Lred
Lw_1:
    s_cmp_lg_u32 s25, 1
    s_cbranch_scc1 Lw_2
    ds_write_b128 v229, v[0:3] offset:20480
    ds_write_b128 v229, v[4:7] offset:21504
    ds_write_b128 v229, v[8:11] offset:22528
    ds_write_b128 v229, v[12:15] offset:23552
    ds_write_b128 v229, v[16:19] offset:24576
    ds_write_b128 v229, v[40:43] offset:25600
    ds_write_b128 v229, v[44:47] offset:26624
    ds_write_b128 v229, v[48:51] offset:27648
    ds_write_b128 v229, v[52:55] offset:28672
    ds_write_b128 v229, v[56:59] offset:29696
    ds_write_b128 v229, v[60:63] offset:30720
    ds_write_b128 v229, v[64:67] offset:31744
    ds_write_b128 v229, v[68:71] offset:32768
    ds_write_b128 v229, v[72:75] offset:33792
    ds_write_b128 v229, v[76:79] offset:34816
    s_waitcnt vmcnt(0)
    ds_write_b64 v242, v[80:81] offset:0
    ds_write_b64 v242, v[82:83] offset:8
    ds_write_b64 v242, v[84:85] offset:4352
    ds_write_b64 v242, v[86:87] offset:4360
    ds_write_b64 v242, v[88:89] offset:8704
    ds_write_b64 v242, v[90:91] offset:8712
    s_waitcnt lgkmcnt(0)
    s_barrier
    ds_read_b128 v[96:99], v229 offset:0
    ds_read_b128 v[100:103], v229 offset:1024
    ds_read_b128 v[104:107], v229 offset:2048
    ds_read_b128 v[108:111], v229 offset:3072
    ds_read_b128 v[112:115], v229 offset:4096
    ds_read_b128 v[116:119], v229 offset:46080
    ds_read_b128 v[120:123], v229 offset:47104
    ds_read_b128 v[124:127], v229 offset:48128
    ds_read_b128 v[128:131], v229 offset:49152
    ds_read_b128 v[132:135], v229 offset:50176
    ds_read_b128 v[136:139], v230 offset:17408
    ds_read_b128 v[140:143], v230 offset:18432
    ds_read_b128 v[144:147], v230 offset:19456
    ds_read_b128 v[148:151], v230 offset:20480
    ds_read_b128 v[152:155], v230 offset:21504
    v_mov_b32 v0, v20
    v_mov_b32 v1, v21
    v_mov_b32 v2, v22
    v_mov_b32 v3, v23
    v_mov_b32 v4, v24
    v_mov_b32 v5, v25
    v_mov_b32 v6, v26
    v_mov_b32 v7, v27
    v_mov_b32 v8, v28
    v_mov_b32 v9, v29
    v_mov_b32 v10, v30
    v_mov_b32 v11, v31
    v_mov_b32 v12, v32
    v_mov_b32 v13, v33
    v_mov_b32 v14, v34
    v_mov_b32 v15, v35
    v_mov_b32 v16, v36
    v_mov_b32 v17, v37
    v_mov_b32 v18, v38
    v_mov_b32 v19, v39
    s_branch Lred
Lw_2:
    s_cmp_lg_u32 s25, 2
    s_cbranch_scc1 Lw_3
    ds_write_b128 v229, v[0:3] offset:40960
    ds_write_b128 v229, v[4:7] offset:41984
    ds_write_b128 v229, v[8:11] offset:43008
    ds_write_b128 v229, v[12:15] offset:44032
    ds_write_b128 v229, v[16:19] offset:45056
    ds_write_b128 v229, v[20:23] offset:46080
    ds_write_b128 v229, v[24:27] offset:47104
    ds_write_b128 v229, v[28:31] offset:48128
    ds_write_b128 v229, v[32:35] offset:49152
    ds_write_b128 v229, v[36:39] offset:50176
    ds_write_b128 v229, v[60:63] offset:51200
    ds_write_b128 v229, v[64:67] offset:52224
    ds_write_b128 v229, v[68:71] offset:53248
    ds_write_b128 v229, v[72:75] offset:54272
    ds_write_b128 v229, v[76:79] offset:55296
    s_waitcnt vmcnt(0)
    ds_write_b64 v242, v[80:81] offset:0
    ds_write_b64 v242, v[82:83] offset:8
    ds_write_b64 v242, v[84:85] offset:4352
    ds_write_b64 v242, v[86:87] offset:4360
    s_waitcnt lgkmcnt(0)
    s_barrier
    ds_read_b128 v[96:99], v229 offset:5120
    ds_read_b128 v[100:103], v229 offset:6144
    ds_read_b128 v[104:107], v229 offset:7168
    ds_read_b128 v[108:111], v229 offset:8192
    ds_read_b128 v[112:115], v229 offset:9216
    ds_read_b128 v[116:119], v229 offset:25600
    ds_read_b128 v[120:123], v229 offset:26624
    ds_read_b128 v[124:127], v229 offset:27648
    ds_read_b128 v[128:131], v229 offset:28672
    ds_read_b128 v[132:135], v229 offset:29696
    ds_read_b128 v[136:139], v230 offset:22528
    ds_read_b128 v[140:143], v230 offset:23552
    ds_read_b128 v[144:147], v230 offset:24576
    ds_read_b128 v[148:151], v230 offset:25600
    ds_read_b128 v[152:155], v230 offset:26624
    v_mov_b32 v0, v40
    v_mov_b32 v1, v41
    v_mov_b32 v2, v42
    v_mov_b32 v3, v43
    v_mov_b32 v4, v44
    v_mov_b32 v5, v45
    v_mov_b32 v6, v46
    v_mov_b32 v7, v47
    v_mov_b32 v8, v48
    v_mov_b32 v9, v49
    v_mov_b32 v10, v50
    v_mov_b32 v11, v51
    v_mov_b32 v12, v52
    v_mov_b32 v13, v53
    v_mov_b32 v14, v54
    v_mov_b32 v15, v55
    v_mov_b32 v16, v56
    v_mov_b32 v17, v57
    v_mov_b32 v18, v58
    v_mov_b32 v19, v59
    s_branch Lred
Lw_3:
    ds_write_b128 v229, v[0:3] offset:61440
    ds_write_b128 v229, v[4:7] offset:62464
    ds_write_b128 v229, v[8:11] offset:63488
    ds_write_b128 v230, v[12:15] offset:15360
    ds_write_b128 v230, v[16:19] offset:16384
    ds_write_b128 v230, v[20:23] offset:17408
    ds_write_b128 v230, v[24:27] offset:18432
    ds_write_b128 v230, v[28:31] offset:19456
    ds_write_b128 v230, v[32:35] offset:20480
    ds_write_b128 v230, v[36:39] offset:21504
    ds_write_b128 v230, v[40:43] offset:22528
    ds_write_b128 v230, v[44:47] offset:23552
    ds_write_b128 v230, v[48:51] offset:24576
    ds_write_b128 v230, v[52:55] offset:25600
    ds_write_b128 v230, v[56:59] offset:26624
    s_waitcnt vmcnt(0)
    ds_write_b64 v242, v[80:81] offset:0
    ds_write_b64 v242, v[82:83] offset:8
    ds_write_b64 v242, v[84:85] offset:4352
    ds_write_b64 v242, v[86:87] offset:4360
    s_waitcnt lgkmcnt(0)
    s_barrier
    ds_read_b128 v[96:99], v229 offset:10240
    ds_read_b128 v[100:103], v229 offset:11264
    ds_read_b128 v[104:107], v229 offset:12288
    ds_read_b128 v[108:111], v229 offset:13312
    ds_read_b128 v[112:115], v229 offset:14336
    ds_read_b128 v[116:119], v229 offset:30720
    ds_read_b128 v[120:123], v229 offset:31744
    ds_read_b128 v[124:127], v229 offset:32768
    ds_read_b128 v[128:131], v229 offset:33792
    ds_read_b128 v[132:135], v229 offset:34816
    ds_read_b128 v[136:139], v229 offset:51200
    ds_read_b128 v[140:143], v229 offset:52224
    ds_read_b128 v[144:147], v229 offset:53248
    ds_read_b128 v[148:151], v229 offset:54272
    ds_read_b128 v[152:155], v229 offset:55296
    v_mov_b32 v0, v60
    v_mov_b32 v1, v61
    v_mov_b32 v2, v62
    v_mov_b32 v3, v63
    v_mov_b32 v4, v64
    v_mov_b32 v5, v65
    v_mov_b32 v6, v66
    v_mov_b32 v7, v67
    v_mov_b32 v8, v68
    v_mov_b32 v9, v69
    v_mov_b32 v10, v70
    v_mov_b32 v11, v71
    v_mov_b32 v12, v72
    v_mov_b32 v13, v73
    v_mov_b32 v14, v74
    v_mov_b32 v15, v75
    v_mov_b32 v16, v76
    v_mov_b32 v17, v77
    v_mov_b32 v18, v78
    v_mov_b32 v19, v79
Lred:
    v_lshrrev_b32 v232, 4, v231
    v_mul_u32_u24 v232, 20, v232
    v_bfe_u32 v233, v231, 2, 2
    v_add_u32 v232, v232, v233
    v_mul_u32_u24 v232, 136, v232
    v_and_b32 v233, 3, v231
    v_lshl_add_u32 v232, v233, 3, v232
    s_lshl_b32 s27, s25, 5
    s_add_u32 s27, s27, 143360
    v_add_u32 v232, s27, v232
    ds_read_b64_tr_b16 v[156:157], v232 offset:0
    ds_read_b64_tr_b16 v[158:159], v232 offset:544
    ds_read_b64_tr_b16 v[160:161], v232 offset:1088
    ds_read_b64_tr_b16 v[162:163], v232 offset:1632
    ds_read_b64_tr_b16 v[164:165], v232 offset:2176
    s_waitcnt lgkmcnt(5)
    v_pk_add_f32 v[0:1], v[0:1], v[96:97]
    v_pk_add_f32 v[2:3], v[2:3], v[98:99]
    v_pk_add_f32 v[4:5], v[4:5], v[100:101]
    v_pk_add_f32 v[6:7], v[6:7], v[102:103]
    v_pk_add_f32 v[8:9], v[8:9], v[104:105]
    v_pk_add_f32 v[10:11], v[10:11], v[106:107]
    v_pk_add_f32 v[12:13], v[12:13], v[108:109]
    v_pk_add_f32 v[14:15], v[14:15], v[110:111]
    v_pk_add_f32 v[16:17], v[16:17], v[112:113]
    v_pk_add_f32 v[18:19], v[18:19], v[114:115]
    v_pk_add_f32 v[0:1], v[0:1], v[116:117]
    v_pk_add_f32 v[2:3], v[2:3], v[118:119]
    v_pk_add_f32 v[4:5], v[4:5], v[120:121]
    v_pk_add_f32 v[6:7], v[6:7], v[122:123]
    v_pk_add_f32 v[8:9], v[8:9], v[124:125]
    v_pk_add_f32 v[10:11], v[10:11], v[126:127]
    v_pk_add_f32 v[12:13], v[12:13], v[128:129]
    v_pk_add_f32 v[14:15], v[14:15], v[130:131]
    v_pk_add_f32 v[16:17], v[16:17], v[132:133]
    v_pk_add_f32 v[18:19], v[18:19], v[134:135]
    v_pk_add_f32 v[0:1], v[0:1], v[136:137]
    v_pk_add_f32 v[2:3], v[2:3], v[138:139]
    v_pk_add_f32 v[4:5], v[4:5], v[140:141]
    v_pk_add_f32 v[6:7], v[6:7], v[142:143]
    v_pk_add_f32 v[8:9], v[8:9], v[144:145]
    v_pk_add_f32 v[10:11], v[10:11], v[146:147]
    v_pk_add_f32 v[12:13], v[12:13], v[148:149]
    v_pk_add_f32 v[14:15], v[14:15], v[150:151]
    v_pk_add_f32 v[16:17], v[16:17], v[152:153]
    v_pk_add_f32 v[18:19], v[18:19], v[154:155]
    s_waitcnt lgkmcnt(0)
    v_lshlrev_b32 v96, 16, v208
    v_and_b32 v97, 0xffff0000, v208
    v_lshlrev_b32 v98, 16, v156
    v_and_b32 v99, 0xffff0000, v156
    v_pk_add_f32 v[0:1], v[0:1], v[96:97]
    v_pk_add_f32 v[0:1], v[0:1], v[98:99]
    v_cvt_pk_bf16_f32 v116, v0, v1
    v_lshlrev_b32 v100, 16, v209
    v_and_b32 v101, 0xffff0000, v209
    v_lshlrev_b32 v102, 16, v157
    v_and_b32 v103, 0xffff0000, v157
    v_pk_add_f32 v[2:3], v[2:3], v[100:101]
    v_pk_add_f32 v[2:3], v[2:3], v[102:103]
    v_cvt_pk_bf16_f32 v117, v2, v3
    v_lshlrev_b32 v104, 16, v210
    v_and_b32 v105, 0xffff0000, v210
    v_lshlrev_b32 v106, 16, v158
    v_and_b32 v107, 0xffff0000, v158
    v_pk_add_f32 v[4:5], v[4:5], v[104:105]
    v_pk_add_f32 v[4:5], v[4:5], v[106:107]
    v_cvt_pk_bf16_f32 v118, v4, v5
    v_lshlrev_b32 v108, 16, v211
    v_and_b32 v109, 0xffff0000, v211
    v_lshlrev_b32 v110, 16, v159
    v_and_b32 v111, 0xffff0000, v159
    v_pk_add_f32 v[6:7], v[6:7], v[108:109]
    v_pk_add_f32 v[6:7], v[6:7], v[110:111]
    v_cvt_pk_bf16_f32 v119, v6, v7
    v_lshlrev_b32 v96, 16, v212
    v_and_b32 v97, 0xffff0000, v212
    v_lshlrev_b32 v98, 16, v160
    v_and_b32 v99, 0xffff0000, v160
    v_pk_add_f32 v[8:9], v[8:9], v[96:97]
    v_pk_add_f32 v[8:9], v[8:9], v[98:99]
    v_cvt_pk_bf16_f32 v120, v8, v9
    v_lshlrev_b32 v100, 16, v213
    v_and_b32 v101, 0xffff0000, v213
    v_lshlrev_b32 v102, 16, v161
    v_and_b32 v103, 0xffff0000, v161
    v_pk_add_f32 v[10:11], v[10:11], v[100:101]
    v_pk_add_f32 v[10:11], v[10:11], v[102:103]
    v_cvt_pk_bf16_f32 v121, v10, v11
    v_lshlrev_b32 v104, 16, v214
    v_and_b32 v105, 0xffff0000, v214
    v_lshlrev_b32 v106, 16, v162
    v_and_b32 v107, 0xffff0000, v162
    v_pk_add_f32 v[12:13], v[12:13], v[104:105]
    v_pk_add_f32 v[12:13], v[12:13], v[106:107]
    v_cvt_pk_bf16_f32 v122, v12, v13
    v_lshlrev_b32 v108, 16, v215
    v_and_b32 v109, 0xffff0000, v215
    v_lshlrev_b32 v110, 16, v163
    v_and_b32 v111, 0xffff0000, v163
    v_pk_add_f32 v[14:15], v[14:15], v[108:109]
    v_pk_add_f32 v[14:15], v[14:15], v[110:111]
    v_cvt_pk_bf16_f32 v123, v14, v15
    v_lshlrev_b32 v96, 16, v216
    v_and_b32 v97, 0xffff0000, v216
    v_lshlrev_b32 v98, 16, v164
    v_and_b32 v99, 0xffff0000, v164
    v_pk_add_f32 v[16:17], v[16:17], v[96:97]
    v_pk_add_f32 v[16:17], v[16:17], v[98:99]
    v_cvt_pk_bf16_f32 v124, v16, v17
    v_lshlrev_b32 v100, 16, v217
    v_and_b32 v101, 0xffff0000, v217
    v_lshlrev_b32 v102, 16, v165
    v_and_b32 v103, 0xffff0000, v165
    v_pk_add_f32 v[18:19], v[18:19], v[100:101]
    v_pk_add_f32 v[18:19], v[18:19], v[102:103]
    v_cvt_pk_bf16_f32 v125, v18, v19
    buffer_store_dwordx4 v[116:119], v240, s[52:55], s40 offen
    buffer_store_dwordx4 v[120:123], v240, s[52:55], s40 offen offset:16
    buffer_store_dwordx2 v[124:125], v240, s[52:55], s40 offen offset:32
    s_branch Lmain_end
Lhrole:
    v_and_b32 v11, 63, v0
    s_mul_i32 s28, s21, 3
    s_lshl_b32 s29, s21, 1
    s_add_u32 s29, s29, 16
    s_cmp_lt_u32 s21, 16
    s_cselect_b32 s28, s28, s29
    s_cselect_b32 s101, 3, 2
    s_mul_i32 s29, s20, 80
    s_add_u32 s28, s28, s29
    s_add_u32 s88, s28, s24
    s_mul_i32 s89, s24, 5888
    s_add_u32 s89, s89, 125696
    s_waitcnt lgkmcnt(0)
    s_mov_b32 s80, s44
    s_mov_b32 s81, s45
    s_mov_b32 s8, s4
    s_and_b32 s9, s5, 0xffff
    s_mov_b32 s10, 2621440
    s_mov_b32 s11, 0x20000
    s_mov_b32 s36, s86
    s_and_b32 s37, s87, 0xffff
    s_mov_b32 s38, 268435456
    s_mov_b32 s39, 0x20000
    s_cmp_eq_u32 s24, 3
    s_cbranch_scc1 Lrole_l
    s_cmp_lt_u32 s24, s101
    s_cbranch_scc0 Lrole_w
    s_mov_b32 s40, s64
    s_and_b32 s41, s65, 0xffff
    s_mov_b32 s42, 245760
    s_mov_b32 s43, 0x20000
    s_mov_b32 s44, s66
    s_and_b32 s45, s67, 0xffff
    s_mov_b32 s46, 245760
    s_mov_b32 s47, 0x20000
    s_mov_b32 s48, s68
    s_and_b32 s49, s69, 0xffff
    s_mov_b32 s50, 245760
    s_mov_b32 s51, 0x20000
    s_mov_b32 s52, s70
    s_and_b32 s53, s71, 0xffff
    s_mov_b32 s54, 245760
    s_mov_b32 s55, 0x20000
    s_mov_b32 s56, s74
    s_and_b32 s57, s75, 0xffff
    s_mov_b32 s58, 1280
    s_mov_b32 s59, 0x20000
    s_mov_b32 s12, s18
    s_and_b32 s13, s19, 0xffff
    s_mov_b32 s14, 1280
    s_mov_b32 s15, 0x20000
    s_setprio 3
    s_mul_i32 s90, s88, 384
    v_lshlrev_b32 v132, 2, v11
    v_lshlrev_b32 v134, 1, v11
    s_lshl_b32 s91, s88, 1
    v_mov_b32 v133, s91
    buffer_load_ushort v44, v133, s[56:59], 0 offen
    buffer_load_dword v32, v132, s[40:43], s90 offen
    buffer_load_dword v33, v132, s[44:47], s90 offen
    buffer_load_dword v34, v132, s[48:51], s90 offen
    buffer_load_dword v35, v132, s[52:55], s90 offen
    buffer_load_ushort v36, v134, s[40:43], s90 offen offset:256
    buffer_load_ushort v37, v134, s[44:47], s90 offen offset:256
    buffer_load_ushort v38, v134, s[48:51], s90 offen offset:256
    buffer_load_ushort v39, v134, s[52:55], s90 offen offset:256
    s_lshl_b32 s29, s88, 1
    v_mov_b32 v30, s29
    buffer_load_ushort v29, v30, s[12:15], 0 offen
    s_setprio 0
    v_lshlrev_b32 v132, 2, v11
    v_lshrrev_b32 v133, 4, v11
    v_add_u32 v48, s89, v132
    v_and_b32 v132, 15, v11
    v_add_u32 v49, 1088, v48
    v_add_u32 v50, 2176, v48
    v_add_u32 v51, 3264, v48
    v_add_u32 v52, 4352, v48
    v_add_u32 v53, 5440, v48
    v_mul_u32_u24 v132, 272, v132
    v_mov_b32 v68, 0
    v_lshl_add_u32 v133, v133, 4, v132
    v_mov_b32 v69, 0
    v_add_u32 v56, s89, v133
    v_mov_b32 v70, 0
    v_mov_b32 v71, 0
    v_mov_b32 v72, 0
    v_mov_b32 v73, 0
    v_mov_b32 v74, 0
    v_mov_b32 v75, 0
    v_mov_b32 v76, 0
    v_mov_b32 v77, 0
    v_mov_b32 v78, 0
    v_mov_b32 v79, 0
    v_mov_b32 v80, 0
    v_mov_b32 v81, 0
    v_mov_b32 v82, 0
    v_mov_b32 v83, 0
    s_waitcnt vmcnt(5)
    v_lshlrev_b32 v44, 16, v44
    v_mul_f32 v44, 0x3fb8aa3b, v44
    v_exp_f32 v44, v44
    s_nop 0
    v_cvt_pk_bf16_f32 v44, v44, v44
    v_lshlrev_b32 v44, 16, v44
    s_waitcnt vmcnt(0)
    v_lshlrev_b32 v132, 16, v32
    v_lshlrev_b32 v133, 16, v33
    v_mul_f32 v132, 0x3fb8aa3b, v132
    v_lshlrev_b32 v134, 16, v34
    v_exp_f32 v132, v132
    v_lshlrev_b32 v135, 16, v35
    v_mul_f32 v133, v133, v44
    v_cvt_pk_bf16_f32 v132, v132, v132
    v_mul_f32 v134, v134, v44
    v_lshlrev_b32 v132, 16, v132
    v_mul_f32 v135, v135, v44
    v_mul_f32 v132, v132, v44
    v_mul_f32 v133, 0.15915494, v133
    v_mul_f32 v132, 0xbfb8aa3b, v132
    v_add_f32 v134, v134, v134
    v_add_f32 v135, v135, v135
    v_mul_f32 v178, 1.0, v132
    v_mul_f32 v179, 1.0, v133
    v_exp_f32 v178, v178
    v_fract_f32 v179, v179
    v_mul_f32 v180, 0x43800000, v132
    v_cos_f32 v136, v179
    v_sin_f32 v137, v179
    v_mul_f32 v181, 0x43800000, v133
    v_mul_f32 v136, v136, v178
    v_mul_f32 v137, v137, v178
    v_exp_f32 v180, v180
    v_sub_f32 v138, 0, v137
    v_fract_f32 v181, v181
    v_mul_f32 v182, 0x41000000, v132
    v_cos_f32 v152, v181
    v_sin_f32 v153, v181
    v_mul_f32 v183, 0x41000000, v133
    v_mul_f32 v152, v152, v180
    v_mul_f32 v153, v153, v180
    v_exp_f32 v182, v182
    v_sub_f32 v154, 0, v153
    v_fract_f32 v183, v183
    v_mul_f32 v140, v136, v136
    v_cos_f32 v148, v183
    v_sin_f32 v149, v183
    v_mul_f32 v141, v136, v137
    v_mul_f32 v148, v148, v182
    v_mul_f32 v149, v149, v182
    v_fmac_f32 v140, v137, v138
    v_sub_f32 v150, 0, v149
    v_add_f32 v141, v141, v141
    v_mul_f32 v156, v148, v148
    v_sub_f32 v142, 0, v141
    v_mul_f32 v157, v148, v149
    v_fmac_f32 v156, v149, v150
    v_add_f32 v157, v157, v157
    v_mul_f32 v144, v140, v140
    v_sub_f32 v158, 0, v157
    v_mul_f32 v145, v140, v141
    v_fmac_f32 v144, v141, v142
    v_add_f32 v145, v145, v145
    v_cvt_pk_bf16_f32 v184, v134, -v135
    v_sub_f32 v146, 0, v145
    v_pk_mul_f32 v[182:183], v[134:135], v[136:137] op_sel:[1,1] op_sel_hi:[1,0] neg_lo:[1,0]
    v_pk_mul_f32 v[176:177], v[134:135], v[152:153] op_sel:[1,1] op_sel_hi:[1,0] neg_lo:[1,0]
    v_pk_fma_f32 v[160:161], v[134:135], v[136:137], v[182:183] op_sel:[0,0,0] op_sel_hi:[0,1,1]
    v_pk_fma_f32 v[164:165], v[134:135], v[152:153], v[176:177] op_sel:[0,0,0] op_sel_hi:[0,1,1]
    v_cvt_pk_bf16_f32 v185, v160, -v161
    v_cvt_pk_bf16_f32 v186, v164, -v165
    ds_write2_b32 v48, v184, v185 offset0:0 offset1:68
    v_pk_mul_f32 v[178:179], v[160:161], v[136:137] op_sel:[1,1] op_sel_hi:[1,0] neg_lo:[1,0]
    v_pk_mul_f32 v[180:181], v[164:165], v[140:141] op_sel:[1,1] op_sel_hi:[1,0] neg_lo:[1,0]
    v_pk_fma_f32 v[162:163], v[160:161], v[136:137], v[178:179] op_sel:[0,0,0] op_sel_hi:[0,1,1]
    v_pk_fma_f32 v[168:169], v[164:165], v[140:141], v[180:181] op_sel:[0,0,0] op_sel_hi:[0,1,1]
    v_pk_mul_f32 v[182:183], v[164:165], v[152:153] op_sel:[1,1] op_sel_hi:[1,0] neg_lo:[1,0]
    v_cvt_pk_bf16_f32 v187, v162, -v163
    v_pk_fma_f32 v[166:167], v[164:165], v[152:153], v[182:183] op_sel:[0,0,0] op_sel_hi:[0,1,1]
    v_cvt_pk_bf16_f32 v188, v168, -v169
    v_cvt_pk_bf16_f32 v189, v166, -v167
    ds_write2_b32 v50, v186, v188 offset0:0 offset1:68
    v_pk_mul_f32 v[176:177], v[162:163], v[136:137] op_sel:[1,1] op_sel_hi:[1,0] neg_lo:[1,0]
    v_pk_mul_f32 v[178:179], v[168:169], v[140:141] op_sel:[1,1] op_sel_hi:[1,0] neg_lo:[1,0]
    v_pk_fma_f32 v[160:161], v[162:163], v[136:137], v[176:177] op_sel:[0,0,0] op_sel_hi:[0,1,1]
    v_pk_fma_f32 v[170:171], v[168:169], v[140:141], v[178:179] op_sel:[0,0,0] op_sel_hi:[0,1,1]
    v_pk_mul_f32 v[180:181], v[166:167], v[144:145] op_sel:[1,1] op_sel_hi:[1,0] neg_lo:[1,0]
    v_pk_mul_f32 v[182:183], v[166:167], v[152:153] op_sel:[1,1] op_sel_hi:[1,0] neg_lo:[1,0]
    v_pk_fma_f32 v[172:173], v[166:167], v[144:145], v[180:181] op_sel:[0,0,0] op_sel_hi:[0,1,1]
    v_pk_fma_f32 v[164:165], v[166:167], v[152:153], v[182:183] op_sel:[0,0,0] op_sel_hi:[0,1,1]
    v_cvt_pk_bf16_f32 v190, v160, -v161
    v_cvt_pk_bf16_f32 v191, v172, -v173
    ds_write2_b32 v48, v187, v190 offset0:136 offset1:204
    ds_write2_b32 v51, v189, v191 offset0:0 offset1:68
    v_cvt_pk_bf16_f32 v184, v170, -v171
    v_cvt_pk_bf16_f32 v185, v164, -v165
    v_pk_mul_f32 v[176:177], v[160:161], v[136:137] op_sel:[1,1] op_sel_hi:[1,0] neg_lo:[1,0]
    v_pk_mul_f32 v[178:179], v[170:171], v[140:141] op_sel:[1,1] op_sel_hi:[1,0] neg_lo:[1,0]
    v_pk_fma_f32 v[162:163], v[160:161], v[136:137], v[176:177] op_sel:[0,0,0] op_sel_hi:[0,1,1]
    v_pk_fma_f32 v[168:169], v[170:171], v[140:141], v[178:179] op_sel:[0,0,0] op_sel_hi:[0,1,1]
    v_pk_mul_f32 v[180:181], v[164:165], v[144:145] op_sel:[1,1] op_sel_hi:[1,0] neg_lo:[1,0]
    v_pk_mul_f32 v[182:183], v[164:165], v[152:153] op_sel:[1,1] op_sel_hi:[1,0] neg_lo:[1,0]
    v_pk_fma_f32 v[174:175], v[164:165], v[144:145], v[180:181] op_sel:[0,0,0] op_sel_hi:[0,1,1]
    v_pk_fma_f32 v[166:167], v[164:165], v[152:153], v[182:183] op_sel:[0,0,0] op_sel_hi:[0,1,1]
    v_cvt_pk_bf16_f32 v186, v168, -v169
    v_cvt_pk_bf16_f32 v187, v174, -v175
    ds_write2_b32 v50, v184, v186 offset0:136 offset1:204
    ds_write2_b32 v51, v185, v187 offset0:136 offset1:204
    v_cvt_pk_bf16_f32 v188, v162, -v163
    v_cvt_pk_bf16_f32 v189, v166, -v167
    v_pk_mul_f32 v[176:177], v[162:163], v[136:137] op_sel:[1,1] op_sel_hi:[1,0] neg_lo:[1,0]
    v_pk_mul_f32 v[178:179], v[166:167], v[152:153] op_sel:[1,1] op_sel_hi:[1,0] neg_lo:[1,0]
    v_pk_fma_f32 v[160:161], v[162:163], v[136:137], v[176:177] op_sel:[0,0,0] op_sel_hi:[0,1,1]
    v_pk_fma_f32 v[164:165], v[166:167], v[152:153], v[178:179] op_sel:[0,0,0] op_sel_hi:[0,1,1]
    v_cvt_pk_bf16_f32 v190, v160, -v161
    v_cvt_pk_bf16_f32 v191, v164, -v165
    ds_write2_b32 v49, v188, v190 offset0:0 offset1:68
    ds_write2_b32 v52, v189, v191 offset0:0 offset1:68
    v_pk_mul_f32 v[180:181], v[160:161], v[136:137] op_sel:[1,1] op_sel_hi:[1,0] neg_lo:[1,0]
    v_pk_mul_f32 v[182:183], v[164:165], v[152:153] op_sel:[1,1] op_sel_hi:[1,0] neg_lo:[1,0]
    v_pk_fma_f32 v[162:163], v[160:161], v[136:137], v[180:181] op_sel:[0,0,0] op_sel_hi:[0,1,1]
    v_pk_fma_f32 v[166:167], v[164:165], v[152:153], v[182:183] op_sel:[0,0,0] op_sel_hi:[0,1,1]
    v_cvt_pk_bf16_f32 v184, v162, -v163
    v_cvt_pk_bf16_f32 v185, v166, -v167
    v_pk_mul_f32 v[176:177], v[162:163], v[136:137] op_sel:[1,1] op_sel_hi:[1,0] neg_lo:[1,0]
    v_pk_mul_f32 v[178:179], v[166:167], v[152:153] op_sel:[1,1] op_sel_hi:[1,0] neg_lo:[1,0]
    v_pk_fma_f32 v[160:161], v[162:163], v[136:137], v[176:177] op_sel:[0,0,0] op_sel_hi:[0,1,1]
    v_pk_fma_f32 v[164:165], v[166:167], v[152:153], v[178:179] op_sel:[0,0,0] op_sel_hi:[0,1,1]
    v_cvt_pk_bf16_f32 v186, v160, -v161
    v_cvt_pk_bf16_f32 v187, v164, -v165
    ds_write2_b32 v49, v184, v186 offset0:136 offset1:204
    ds_write2_b32 v52, v185, v187 offset0:136 offset1:204
    v_pk_mul_f32 v[180:181], v[164:165], v[152:153] op_sel:[1,1] op_sel_hi:[1,0] neg_lo:[1,0]
    v_mov_b32 v189, 0x3f80
    v_pk_fma_f32 v[166:167], v[164:165], v[152:153], v[180:181] op_sel:[0,0,0] op_sel_hi:[0,1,1]
    v_cvt_pk_bf16_f32 v190, v148, v149
    v_cvt_pk_bf16_f32 v188, v166, -v167
    v_pk_mul_f32 v[182:183], v[148:149], v[156:157] op_sel:[1,1] op_sel_hi:[1,0] neg_lo:[1,0]
    ds_write_b32 v53, v188 offset:0
    ds_read_b128 v[84:87], v56 offset:0
    ds_read_b128 v[88:91], v56 offset:64
    ds_read_b128 v[92:95], v56 offset:128
    ds_read_b128 v[96:99], v56 offset:192
    ds_read_b128 v[100:103], v56 offset:4352
    ds_read_b128 v[104:107], v56 offset:4416
    ds_read_b128 v[108:111], v56 offset:4480
    ds_read_b128 v[112:115], v56 offset:4544
    ds_write2_b32 v48, v189, v190 offset0:0 offset1:68
    v_pk_fma_f32 v[168:169], v[148:149], v[156:157], v[182:183] op_sel:[0,0,0] op_sel_hi:[0,1,1]
    v_cvt_pk_bf16_f32 v191, v156, v157
    v_cvt_pk_bf16_f32 v184, v168, v169
    v_pk_mul_f32 v[176:177], v[156:157], v[156:157] op_sel:[1,1] op_sel_hi:[1,0] neg_lo:[1,0]
    ds_write2_b32 v48, v191, v184 offset0:136 offset1:204
    v_pk_fma_f32 v[160:161], v[156:157], v[156:157], v[176:177] op_sel:[0,0,0] op_sel_hi:[0,1,1]
    v_pk_mul_f32 v[178:179], v[168:169], v[156:157] op_sel:[1,1] op_sel_hi:[1,0] neg_lo:[1,0]
    v_cvt_pk_bf16_f32 v185, v160, v161
    v_pk_fma_f32 v[170:171], v[168:169], v[156:157], v[178:179] op_sel:[0,0,0] op_sel_hi:[0,1,1]
    v_pk_mul_f32 v[180:181], v[160:161], v[156:157] op_sel:[1,1] op_sel_hi:[1,0] neg_lo:[1,0]
    v_cvt_pk_bf16_f32 v186, v170, v171
    v_pk_fma_f32 v[162:163], v[160:161], v[156:157], v[180:181] op_sel:[0,0,0] op_sel_hi:[0,1,1]
    ds_write2_b32 v49, v185, v186 offset0:0 offset1:68
    v_pk_mul_f32 v[182:183], v[170:171], v[156:157] op_sel:[1,1] op_sel_hi:[1,0] neg_lo:[1,0]
    v_cvt_pk_bf16_f32 v187, v162, v163
    v_pk_fma_f32 v[168:169], v[170:171], v[156:157], v[182:183] op_sel:[0,0,0] op_sel_hi:[0,1,1]
    v_pk_mul_f32 v[176:177], v[162:163], v[156:157] op_sel:[1,1] op_sel_hi:[1,0] neg_lo:[1,0]
    v_cvt_pk_bf16_f32 v188, v168, v169
    v_pk_fma_f32 v[160:161], v[162:163], v[156:157], v[176:177] op_sel:[0,0,0] op_sel_hi:[0,1,1]
    ds_write2_b32 v49, v187, v188 offset0:136 offset1:204
    v_pk_mul_f32 v[178:179], v[168:169], v[156:157] op_sel:[1,1] op_sel_hi:[1,0] neg_lo:[1,0]
    v_cvt_pk_bf16_f32 v189, v160, v161
    v_pk_fma_f32 v[170:171], v[168:169], v[156:157], v[178:179] op_sel:[0,0,0] op_sel_hi:[0,1,1]
    v_pk_mul_f32 v[180:181], v[160:161], v[156:157] op_sel:[1,1] op_sel_hi:[1,0] neg_lo:[1,0]
    v_cvt_pk_bf16_f32 v190, v170, v171
    v_pk_fma_f32 v[162:163], v[160:161], v[156:157], v[180:181] op_sel:[0,0,0] op_sel_hi:[0,1,1]
    ds_write2_b32 v50, v189, v190 offset0:0 offset1:68
    v_pk_mul_f32 v[182:183], v[170:171], v[156:157] op_sel:[1,1] op_sel_hi:[1,0] neg_lo:[1,0]
    v_cvt_pk_bf16_f32 v191, v162, v163
    v_pk_fma_f32 v[168:169], v[170:171], v[156:157], v[182:183] op_sel:[0,0,0] op_sel_hi:[0,1,1]
    v_pk_mul_f32 v[176:177], v[162:163], v[156:157] op_sel:[1,1] op_sel_hi:[1,0] neg_lo:[1,0]
    v_cvt_pk_bf16_f32 v184, v168, v169
    v_pk_fma_f32 v[160:161], v[162:163], v[156:157], v[176:177] op_sel:[0,0,0] op_sel_hi:[0,1,1]
    ds_write2_b32 v50, v191, v184 offset0:136 offset1:204
    v_pk_mul_f32 v[178:179], v[168:169], v[156:157] op_sel:[1,1] op_sel_hi:[1,0] neg_lo:[1,0]
    v_cvt_pk_bf16_f32 v185, v160, v161
    v_pk_fma_f32 v[170:171], v[168:169], v[156:157], v[178:179] op_sel:[0,0,0] op_sel_hi:[0,1,1]
    v_pk_mul_f32 v[180:181], v[160:161], v[156:157] op_sel:[1,1] op_sel_hi:[1,0] neg_lo:[1,0]
    v_cvt_pk_bf16_f32 v186, v170, v171
    v_pk_fma_f32 v[162:163], v[160:161], v[156:157], v[180:181] op_sel:[0,0,0] op_sel_hi:[0,1,1]
    ds_write2_b32 v51, v185, v186 offset0:0 offset1:68
    v_pk_mul_f32 v[182:183], v[170:171], v[156:157] op_sel:[1,1] op_sel_hi:[1,0] neg_lo:[1,0]
    v_cvt_pk_bf16_f32 v187, v162, v163
    v_pk_fma_f32 v[168:169], v[170:171], v[156:157], v[182:183] op_sel:[0,0,0] op_sel_hi:[0,1,1]
    v_pk_mul_f32 v[176:177], v[162:163], v[156:157] op_sel:[1,1] op_sel_hi:[1,0] neg_lo:[1,0]
    v_cvt_pk_bf16_f32 v188, v168, v169
    v_pk_fma_f32 v[160:161], v[162:163], v[156:157], v[176:177] op_sel:[0,0,0] op_sel_hi:[0,1,1]
    ds_write2_b32 v51, v187, v188 offset0:136 offset1:204
    ds_read_b128 v[116:119], v56 offset:0
    ds_read_b128 v[120:123], v56 offset:64
    ds_read_b128 v[124:127], v56 offset:128
    ds_read_b128 v[128:131], v56 offset:192
    v_pk_mul_f32 v[178:179], v[168:169], v[156:157] op_sel:[1,1] op_sel_hi:[1,0] neg_lo:[1,0]
    v_cvt_pk_bf16_f32 v189, v160, v161
    v_pk_fma_f32 v[170:171], v[168:169], v[156:157], v[178:179] op_sel:[0,0,0] op_sel_hi:[0,1,1]
    v_pk_mul_f32 v[180:181], v[160:161], v[156:157] op_sel:[1,1] op_sel_hi:[1,0] neg_lo:[1,0]
    v_cvt_pk_bf16_f32 v190, v170, v171
    v_pk_fma_f32 v[162:163], v[160:161], v[156:157], v[180:181] op_sel:[0,0,0] op_sel_hi:[0,1,1]
    ds_write2_b32 v48, v189, v190 offset0:0 offset1:68
    v_pk_mul_f32 v[182:183], v[170:171], v[156:157] op_sel:[1,1] op_sel_hi:[1,0] neg_lo:[1,0]
    v_cvt_pk_bf16_f32 v191, v162, v163
    v_pk_fma_f32 v[168:169], v[170:171], v[156:157], v[182:183] op_sel:[0,0,0] op_sel_hi:[0,1,1]
    v_pk_mul_f32 v[176:177], v[162:163], v[156:157] op_sel:[1,1] op_sel_hi:[1,0] neg_lo:[1,0]
    v_cvt_pk_bf16_f32 v184, v168, v169
    v_pk_fma_f32 v[160:161], v[162:163], v[156:157], v[176:177] op_sel:[0,0,0] op_sel_hi:[0,1,1]
    ds_write2_b32 v48, v191, v184 offset0:136 offset1:204
    v_pk_mul_f32 v[178:179], v[168:169], v[156:157] op_sel:[1,1] op_sel_hi:[1,0] neg_lo:[1,0]
    v_cvt_pk_bf16_f32 v185, v160, v161
    v_pk_fma_f32 v[170:171], v[168:169], v[156:157], v[178:179] op_sel:[0,0,0] op_sel_hi:[0,1,1]
    v_pk_mul_f32 v[180:181], v[160:161], v[156:157] op_sel:[1,1] op_sel_hi:[1,0] neg_lo:[1,0]
    v_cvt_pk_bf16_f32 v186, v170, v171
    v_pk_fma_f32 v[162:163], v[160:161], v[156:157], v[180:181] op_sel:[0,0,0] op_sel_hi:[0,1,1]
    ds_write2_b32 v49, v185, v186 offset0:0 offset1:68
    v_pk_mul_f32 v[182:183], v[170:171], v[156:157] op_sel:[1,1] op_sel_hi:[1,0] neg_lo:[1,0]
    v_cvt_pk_bf16_f32 v187, v162, v163
    v_pk_fma_f32 v[168:169], v[170:171], v[156:157], v[182:183] op_sel:[0,0,0] op_sel_hi:[0,1,1]
    v_pk_mul_f32 v[176:177], v[162:163], v[156:157] op_sel:[1,1] op_sel_hi:[1,0] neg_lo:[1,0]
    v_cvt_pk_bf16_f32 v188, v168, v169
    v_pk_fma_f32 v[160:161], v[162:163], v[156:157], v[176:177] op_sel:[0,0,0] op_sel_hi:[0,1,1]
    ds_write2_b32 v49, v187, v188 offset0:136 offset1:204
    v_pk_mul_f32 v[178:179], v[168:169], v[156:157] op_sel:[1,1] op_sel_hi:[1,0] neg_lo:[1,0]
    v_cvt_pk_bf16_f32 v189, v160, v161
    v_pk_fma_f32 v[170:171], v[168:169], v[156:157], v[178:179] op_sel:[0,0,0] op_sel_hi:[0,1,1]
    v_pk_mul_f32 v[180:181], v[160:161], v[156:157] op_sel:[1,1] op_sel_hi:[1,0] neg_lo:[1,0]
    v_cvt_pk_bf16_f32 v190, v170, v171
    v_pk_fma_f32 v[162:163], v[160:161], v[156:157], v[180:181] op_sel:[0,0,0] op_sel_hi:[0,1,1]
    ds_write2_b32 v50, v189, v190 offset0:0 offset1:68
    v_pk_mul_f32 v[182:183], v[170:171], v[156:157] op_sel:[1,1] op_sel_hi:[1,0] neg_lo:[1,0]
    v_cvt_pk_bf16_f32 v191, v162, v163
    v_pk_fma_f32 v[168:169], v[170:171], v[156:157], v[182:183] op_sel:[0,0,0] op_sel_hi:[0,1,1]
    v_pk_mul_f32 v[176:177], v[162:163], v[156:157] op_sel:[1,1] op_sel_hi:[1,0] neg_lo:[1,0]
    v_cvt_pk_bf16_f32 v184, v168, v169
    v_pk_fma_f32 v[160:161], v[162:163], v[156:157], v[176:177] op_sel:[0,0,0] op_sel_hi:[0,1,1]
    ds_write2_b32 v50, v191, v184 offset0:136 offset1:204
    v_pk_mul_f32 v[178:179], v[168:169], v[156:157] op_sel:[1,1] op_sel_hi:[1,0] neg_lo:[1,0]
    v_cvt_pk_bf16_f32 v185, v160, v161
    v_pk_fma_f32 v[170:171], v[168:169], v[156:157], v[178:179] op_sel:[0,0,0] op_sel_hi:[0,1,1]
    v_pk_mul_f32 v[180:181], v[160:161], v[156:157] op_sel:[1,1] op_sel_hi:[1,0] neg_lo:[1,0]
    v_cvt_pk_bf16_f32 v186, v170, v171
    v_pk_fma_f32 v[162:163], v[160:161], v[156:157], v[180:181] op_sel:[0,0,0] op_sel_hi:[0,1,1]
    ds_write2_b32 v51, v185, v186 offset0:0 offset1:68
    v_pk_mul_f32 v[182:183], v[170:171], v[156:157] op_sel:[1,1] op_sel_hi:[1,0] neg_lo:[1,0]
    v_cvt_pk_bf16_f32 v187, v162, v163
    v_pk_fma_f32 v[168:169], v[170:171], v[156:157], v[182:183] op_sel:[0,0,0] op_sel_hi:[0,1,1]
    v_cvt_pk_bf16_f32 v188, v168, v169
    ds_write2_b32 v51, v187, v188 offset0:136 offset1:204
    s_waitcnt lgkmcnt(8)
    s_setprio 1
    v_mfma_f32_16x16x32_bf16 v[68:71], v[84:87], v[116:119], v[68:71]
    v_mfma_f32_16x16x32_bf16 v[76:79], v[100:103], v[116:119], v[76:79]
    v_mfma_f32_16x16x32_bf16 v[68:71], v[88:91], v[120:123], v[68:71]
    v_mfma_f32_16x16x32_bf16 v[76:79], v[104:107], v[120:123], v[76:79]
    v_mfma_f32_16x16x32_bf16 v[68:71], v[92:95], v[124:127], v[68:71]
    v_mfma_f32_16x16x32_bf16 v[76:79], v[108:111], v[124:127], v[76:79]
    v_mfma_f32_16x16x32_bf16 v[68:71], v[96:99], v[128:131], v[68:71]
    v_mfma_f32_16x16x32_bf16 v[76:79], v[112:115], v[128:131], v[76:79]
    s_setprio 0
    ds_read_b128 v[116:119], v56 offset:0
    ds_read_b128 v[120:123], v56 offset:64
    ds_read_b128 v[124:127], v56 offset:128
    ds_read_b128 v[128:131], v56 offset:192
    s_waitcnt lgkmcnt(0)
    s_setprio 1
    v_mfma_f32_16x16x32_bf16 v[72:75], v[84:87], v[116:119], v[72:75]
    v_mfma_f32_16x16x32_bf16 v[80:83], v[100:103], v[116:119], v[80:83]
    v_mfma_f32_16x16x32_bf16 v[72:75], v[88:91], v[120:123], v[72:75]
    v_mfma_f32_16x16x32_bf16 v[80:83], v[104:107], v[120:123], v[80:83]
    v_mfma_f32_16x16x32_bf16 v[72:75], v[92:95], v[124:127], v[72:75]
    v_mfma_f32_16x16x32_bf16 v[80:83], v[108:111], v[124:127], v[80:83]
    v_mfma_f32_16x16x32_bf16 v[72:75], v[96:99], v[128:131], v[72:75]
    v_mfma_f32_16x16x32_bf16 v[80:83], v[112:115], v[128:131], v[80:83]
    s_setprio 0
    s_barrier
    v_and_b32 v132, 0xffff0000, v32
    v_and_b32 v133, 0xffff0000, v33
    v_mul_f32 v132, 0x3fb8aa3b, v132
    v_and_b32 v134, 0xffff0000, v34
    v_exp_f32 v132, v132
    v_and_b32 v135, 0xffff0000, v35
    v_mul_f32 v133, v133, v44
    v_cvt_pk_bf16_f32 v132, v132, v132
    v_mul_f32 v134, v134, v44
    v_lshlrev_b32 v132, 16, v132
    v_mul_f32 v135, v135, v44
    v_mul_f32 v132, v132, v44
    v_mul_f32 v133, 0.15915494, v133
    v_mul_f32 v132, 0xbfb8aa3b, v132
    v_add_f32 v134, v134, v134
    v_add_f32 v135, v135, v135
    v_mul_f32 v178, 1.0, v132
    v_mul_f32 v179, 1.0, v133
    v_exp_f32 v178, v178
    v_fract_f32 v179, v179
    v_mul_f32 v180, 0x43800000, v132
    v_cos_f32 v136, v179
    v_sin_f32 v137, v179
    v_mul_f32 v181, 0x43800000, v133
    v_mul_f32 v136, v136, v178
    v_mul_f32 v137, v137, v178
    v_exp_f32 v180, v180
    v_sub_f32 v138, 0, v137
    v_fract_f32 v181, v181
    v_mul_f32 v182, 0x41000000, v132
    v_cos_f32 v152, v181
    v_sin_f32 v153, v181
    v_mul_f32 v183, 0x41000000, v133
    v_mul_f32 v152, v152, v180
    v_mul_f32 v153, v153, v180
    v_exp_f32 v182, v182
    v_sub_f32 v154, 0, v153
    v_fract_f32 v183, v183
    v_mul_f32 v140, v136, v136
    v_cos_f32 v148, v183
    v_sin_f32 v149, v183
    v_mul_f32 v141, v136, v137
    v_mul_f32 v148, v148, v182
    v_mul_f32 v149, v149, v182
    v_fmac_f32 v140, v137, v138
    v_sub_f32 v150, 0, v149
    v_add_f32 v141, v141, v141
    v_mul_f32 v156, v148, v148
    v_sub_f32 v142, 0, v141
    v_mul_f32 v157, v148, v149
    v_fmac_f32 v156, v149, v150
    v_add_f32 v157, v157, v157
    v_mul_f32 v144, v140, v140
    v_sub_f32 v158, 0, v157
    v_mul_f32 v145, v140, v141
    v_fmac_f32 v144, v141, v142
    v_add_f32 v145, v145, v145
    v_cvt_pk_bf16_f32 v184, v134, -v135
    v_sub_f32 v146, 0, v145
    v_mul_f32 v160, v134, v136
    v_mul_f32 v161, v134, v137
    v_fmac_f32 v160, v135, v138
    v_fmac_f32 v161, v135, v136
    v_mul_f32 v164, v134, v152
    v_mul_f32 v165, v134, v153
    v_fmac_f32 v164, v135, v154
    v_fmac_f32 v165, v135, v152
    v_cvt_pk_bf16_f32 v185, v160, -v161
    v_cvt_pk_bf16_f32 v186, v164, -v165
    ds_write2_b32 v48, v184, v185 offset0:0 offset1:68
    v_mul_f32 v162, v160, v136
    v_mul_f32 v163, v160, v137
    v_fmac_f32 v162, v161, v138
    v_fmac_f32 v163, v161, v136
    v_mul_f32 v168, v164, v140
    v_mul_f32 v169, v164, v141
    v_fmac_f32 v168, v165, v142
    v_fmac_f32 v169, v165, v140
    v_mul_f32 v166, v164, v152
    v_mul_f32 v167, v164, v153
    v_fmac_f32 v166, v165, v154
    v_fmac_f32 v167, v165, v152
    v_cvt_pk_bf16_f32 v187, v162, -v163
    v_cvt_pk_bf16_f32 v188, v168, -v169
    v_cvt_pk_bf16_f32 v189, v166, -v167
    ds_write2_b32 v50, v186, v188 offset0:0 offset1:68
    v_mul_f32 v160, v162, v136
    v_mul_f32 v161, v162, v137
    v_fmac_f32 v160, v163, v138
    v_fmac_f32 v161, v163, v136
    v_mul_f32 v170, v168, v140
    v_mul_f32 v171, v168, v141
    v_fmac_f32 v170, v169, v142
    v_fmac_f32 v171, v169, v140
    v_mul_f32 v172, v166, v144
    v_mul_f32 v173, v166, v145
    v_fmac_f32 v172, v167, v146
    v_fmac_f32 v173, v167, v144
    v_mul_f32 v164, v166, v152
    v_mul_f32 v165, v166, v153
    v_fmac_f32 v164, v167, v154
    v_fmac_f32 v165, v167, v152
    v_cvt_pk_bf16_f32 v190, v160, -v161
    v_cvt_pk_bf16_f32 v191, v172, -v173
    ds_write2_b32 v48, v187, v190 offset0:136 offset1:204
    ds_write2_b32 v51, v189, v191 offset0:0 offset1:68
    s_barrier
    v_cvt_pk_bf16_f32 v184, v170, -v171
    v_cvt_pk_bf16_f32 v185, v164, -v165
    v_mul_f32 v162, v160, v136
    v_mul_f32 v163, v160, v137
    v_fmac_f32 v162, v161, v138
    v_fmac_f32 v163, v161, v136
    v_mul_f32 v168, v170, v140
    v_mul_f32 v169, v170, v141
    v_fmac_f32 v168, v171, v142
    v_fmac_f32 v169, v171, v140
    v_mul_f32 v174, v164, v144
    v_mul_f32 v175, v164, v145
    v_fmac_f32 v174, v165, v146
    v_fmac_f32 v175, v165, v144
    v_mul_f32 v166, v164, v152
    v_mul_f32 v167, v164, v153
    v_fmac_f32 v166, v165, v154
    v_fmac_f32 v167, v165, v152
    v_cvt_pk_bf16_f32 v186, v168, -v169
    v_cvt_pk_bf16_f32 v187, v174, -v175
    ds_write2_b32 v50, v184, v186 offset0:136 offset1:204
    ds_write2_b32 v51, v185, v187 offset0:136 offset1:204
    v_cvt_pk_bf16_f32 v188, v162, -v163
    v_cvt_pk_bf16_f32 v189, v166, -v167
    v_mul_f32 v160, v162, v136
    v_mul_f32 v161, v162, v137
    v_fmac_f32 v160, v163, v138
    v_fmac_f32 v161, v163, v136
    v_mul_f32 v164, v166, v152
    v_mul_f32 v165, v166, v153
    v_fmac_f32 v164, v167, v154
    v_fmac_f32 v165, v167, v152
    v_cvt_pk_bf16_f32 v190, v160, -v161
    v_cvt_pk_bf16_f32 v191, v164, -v165
    ds_write2_b32 v49, v188, v190 offset0:0 offset1:68
    ds_write2_b32 v52, v189, v191 offset0:0 offset1:68
    v_mul_f32 v162, v160, v136
    v_mul_f32 v163, v160, v137
    v_fmac_f32 v162, v161, v138
    v_fmac_f32 v163, v161, v136
    v_mul_f32 v166, v164, v152
    v_mul_f32 v167, v164, v153
    v_fmac_f32 v166, v165, v154
    v_fmac_f32 v167, v165, v152
    v_cvt_pk_bf16_f32 v184, v162, -v163
    v_cvt_pk_bf16_f32 v185, v166, -v167
    v_mul_f32 v160, v162, v136
    v_mul_f32 v161, v162, v137
    v_fmac_f32 v160, v163, v138
    v_fmac_f32 v161, v163, v136
    v_mul_f32 v164, v166, v152
    v_mul_f32 v165, v166, v153
    v_fmac_f32 v164, v167, v154
    v_fmac_f32 v165, v167, v152
    v_cvt_pk_bf16_f32 v186, v160, -v161
    v_cvt_pk_bf16_f32 v187, v164, -v165
    ds_write2_b32 v49, v184, v186 offset0:136 offset1:204
    ds_write2_b32 v52, v185, v187 offset0:136 offset1:204
    v_mul_f32 v166, v164, v152
    v_mul_f32 v167, v164, v153
    v_fmac_f32 v166, v165, v154
    v_fmac_f32 v167, v165, v152
    v_mov_b32 v189, 0x3f80
    v_cvt_pk_bf16_f32 v188, v166, -v167
    v_cvt_pk_bf16_f32 v190, v148, v149
    ds_write_b32 v53, v188 offset:0
    ds_read_b128 v[84:87], v56 offset:0
    ds_read_b128 v[88:91], v56 offset:64
    ds_read_b128 v[92:95], v56 offset:128
    ds_read_b128 v[96:99], v56 offset:192
    ds_read_b128 v[100:103], v56 offset:4352
    ds_read_b128 v[104:107], v56 offset:4416
    ds_read_b128 v[108:111], v56 offset:4480
    ds_read_b128 v[112:115], v56 offset:4544
    ds_write2_b32 v48, v189, v190 offset0:0 offset1:68
    v_mul_f32 v168, v148, v156
    v_mul_f32 v169, v148, v157
    v_fmac_f32 v168, v149, v158
    v_fmac_f32 v169, v149, v156
    v_cvt_pk_bf16_f32 v191, v156, v157
    v_cvt_pk_bf16_f32 v184, v168, v169
    v_mul_f32 v160, v156, v156
    ds_write2_b32 v48, v191, v184 offset0:136 offset1:204
    v_mul_f32 v161, v156, v157
    v_fmac_f32 v160, v157, v158
    v_fmac_f32 v161, v157, v156
    v_mul_f32 v170, v168, v156
    v_mul_f32 v171, v168, v157
    s_barrier
    v_fmac_f32 v170, v169, v158
    v_fmac_f32 v171, v169, v156
    v_cvt_pk_bf16_f32 v185, v160, v161
    v_cvt_pk_bf16_f32 v186, v170, v171
    v_mul_f32 v162, v160, v156
    ds_write2_b32 v49, v185, v186 offset0:0 offset1:68
    v_mul_f32 v163, v160, v157
    v_fmac_f32 v162, v161, v158
    v_fmac_f32 v163, v161, v156
    v_mul_f32 v168, v170, v156
    v_mul_f32 v169, v170, v157
    v_fmac_f32 v168, v171, v158
    v_fmac_f32 v169, v171, v156
    v_cvt_pk_bf16_f32 v187, v162, v163
    v_cvt_pk_bf16_f32 v188, v168, v169
    v_mul_f32 v160, v162, v156
    ds_write2_b32 v49, v187, v188 offset0:136 offset1:204
    v_mul_f32 v161, v162, v157
    v_fmac_f32 v160, v163, v158
    v_fmac_f32 v161, v163, v156
    v_mul_f32 v170, v168, v156
    v_mul_f32 v171, v168, v157
    v_fmac_f32 v170, v169, v158
    v_fmac_f32 v171, v169, v156
    v_cvt_pk_bf16_f32 v189, v160, v161
    v_cvt_pk_bf16_f32 v190, v170, v171
    v_mul_f32 v162, v160, v156
    ds_write2_b32 v50, v189, v190 offset0:0 offset1:68
    v_mul_f32 v163, v160, v157
    v_fmac_f32 v162, v161, v158
    v_fmac_f32 v163, v161, v156
    v_mul_f32 v168, v170, v156
    v_mul_f32 v169, v170, v157
    v_fmac_f32 v168, v171, v158
    v_fmac_f32 v169, v171, v156
    v_cvt_pk_bf16_f32 v191, v162, v163
    v_cvt_pk_bf16_f32 v184, v168, v169
    v_mul_f32 v160, v162, v156
    ds_write2_b32 v50, v191, v184 offset0:136 offset1:204
    v_mul_f32 v161, v162, v157
    v_fmac_f32 v160, v163, v158
    v_fmac_f32 v161, v163, v156
    v_mul_f32 v170, v168, v156
    v_mul_f32 v171, v168, v157
    v_fmac_f32 v170, v169, v158
    v_fmac_f32 v171, v169, v156
    v_cvt_pk_bf16_f32 v185, v160, v161
    v_cvt_pk_bf16_f32 v186, v170, v171
    v_mul_f32 v162, v160, v156
    ds_write2_b32 v51, v185, v186 offset0:0 offset1:68
    v_mul_f32 v163, v160, v157
    v_fmac_f32 v162, v161, v158
    v_fmac_f32 v163, v161, v156
    v_mul_f32 v168, v170, v156
    v_mul_f32 v169, v170, v157
    v_fmac_f32 v168, v171, v158
    v_fmac_f32 v169, v171, v156
    v_cvt_pk_bf16_f32 v187, v162, v163
    v_cvt_pk_bf16_f32 v188, v168, v169
    v_mul_f32 v160, v162, v156
    ds_write2_b32 v51, v187, v188 offset0:136 offset1:204
    ds_read_b128 v[116:119], v56 offset:0
    ds_read_b128 v[120:123], v56 offset:64
    ds_read_b128 v[124:127], v56 offset:128
    ds_read_b128 v[128:131], v56 offset:192
    v_mul_f32 v161, v162, v157
    v_fmac_f32 v160, v163, v158
    v_fmac_f32 v161, v163, v156
    v_mul_f32 v170, v168, v156
    v_mul_f32 v171, v168, v157
    v_fmac_f32 v170, v169, v158
    v_fmac_f32 v171, v169, v156
    v_cvt_pk_bf16_f32 v189, v160, v161
    v_cvt_pk_bf16_f32 v190, v170, v171
    v_mul_f32 v162, v160, v156
    ds_write2_b32 v48, v189, v190 offset0:0 offset1:68
    v_mul_f32 v163, v160, v157
    v_fmac_f32 v162, v161, v158
    v_fmac_f32 v163, v161, v156
    v_mul_f32 v168, v170, v156
    v_mul_f32 v169, v170, v157
    v_fmac_f32 v168, v171, v158
    v_fmac_f32 v169, v171, v156
    v_cvt_pk_bf16_f32 v191, v162, v163
    v_cvt_pk_bf16_f32 v184, v168, v169
    v_mul_f32 v160, v162, v156
    ds_write2_b32 v48, v191, v184 offset0:136 offset1:204
    v_mul_f32 v161, v162, v157
    v_fmac_f32 v160, v163, v158
    v_fmac_f32 v161, v163, v156
    v_mul_f32 v170, v168, v156
    v_mul_f32 v171, v168, v157
    s_barrier
    v_fmac_f32 v170, v169, v158
    v_fmac_f32 v171, v169, v156
    v_cvt_pk_bf16_f32 v185, v160, v161
    v_cvt_pk_bf16_f32 v186, v170, v171
    v_mul_f32 v162, v160, v156
    ds_write2_b32 v49, v185, v186 offset0:0 offset1:68
    v_mul_f32 v163, v160, v157
    v_fmac_f32 v162, v161, v158
    v_fmac_f32 v163, v161, v156
    v_mul_f32 v168, v170, v156
    v_mul_f32 v169, v170, v157
    v_fmac_f32 v168, v171, v158
    v_fmac_f32 v169, v171, v156
    v_cvt_pk_bf16_f32 v187, v162, v163
    v_cvt_pk_bf16_f32 v188, v168, v169
    v_mul_f32 v160, v162, v156
    ds_write2_b32 v49, v187, v188 offset0:136 offset1:204
    v_mul_f32 v161, v162, v157
    v_fmac_f32 v160, v163, v158
    v_fmac_f32 v161, v163, v156
    v_mul_f32 v170, v168, v156
    v_mul_f32 v171, v168, v157
    v_fmac_f32 v170, v169, v158
    v_fmac_f32 v171, v169, v156
    v_cvt_pk_bf16_f32 v189, v160, v161
    v_cvt_pk_bf16_f32 v190, v170, v171
    v_mul_f32 v162, v160, v156
    ds_write2_b32 v50, v189, v190 offset0:0 offset1:68
    v_mul_f32 v163, v160, v157
    v_fmac_f32 v162, v161, v158
    v_fmac_f32 v163, v161, v156
    v_mul_f32 v168, v170, v156
    v_mul_f32 v169, v170, v157
    v_fmac_f32 v168, v171, v158
    v_fmac_f32 v169, v171, v156
    v_cvt_pk_bf16_f32 v191, v162, v163
    v_cvt_pk_bf16_f32 v184, v168, v169
    v_mul_f32 v160, v162, v156
    ds_write2_b32 v50, v191, v184 offset0:136 offset1:204
    v_mul_f32 v161, v162, v157
    v_fmac_f32 v160, v163, v158
    v_fmac_f32 v161, v163, v156
    v_mul_f32 v170, v168, v156
    v_mul_f32 v171, v168, v157
    v_fmac_f32 v170, v169, v158
    v_fmac_f32 v171, v169, v156
    v_cvt_pk_bf16_f32 v185, v160, v161
    v_cvt_pk_bf16_f32 v186, v170, v171
    v_mul_f32 v162, v160, v156
    ds_write2_b32 v51, v185, v186 offset0:0 offset1:68
    v_mul_f32 v163, v160, v157
    v_fmac_f32 v162, v161, v158
    v_fmac_f32 v163, v161, v156
    v_mul_f32 v168, v170, v156
    v_mul_f32 v169, v170, v157
    v_fmac_f32 v168, v171, v158
    v_fmac_f32 v169, v171, v156
    v_cvt_pk_bf16_f32 v187, v162, v163
    v_cvt_pk_bf16_f32 v188, v168, v169
    ds_write2_b32 v51, v187, v188 offset0:136 offset1:204
    s_waitcnt lgkmcnt(8)
    s_setprio 1
    v_mfma_f32_16x16x32_bf16 v[68:71], v[84:87], v[116:119], v[68:71]
    v_mfma_f32_16x16x32_bf16 v[76:79], v[100:103], v[116:119], v[76:79]
    v_mfma_f32_16x16x32_bf16 v[68:71], v[88:91], v[120:123], v[68:71]
    v_mfma_f32_16x16x32_bf16 v[76:79], v[104:107], v[120:123], v[76:79]
    v_mfma_f32_16x16x32_bf16 v[68:71], v[92:95], v[124:127], v[68:71]
    v_mfma_f32_16x16x32_bf16 v[76:79], v[108:111], v[124:127], v[76:79]
    v_mfma_f32_16x16x32_bf16 v[68:71], v[96:99], v[128:131], v[68:71]
    v_mfma_f32_16x16x32_bf16 v[76:79], v[112:115], v[128:131], v[76:79]
    s_setprio 0
    ds_read_b128 v[116:119], v56 offset:0
    ds_read_b128 v[120:123], v56 offset:64
    ds_read_b128 v[124:127], v56 offset:128
    ds_read_b128 v[128:131], v56 offset:192
    v_lshlrev_b32 v132, 16, v36
    v_lshlrev_b32 v133, 16, v37
    s_barrier
    v_mul_f32 v132, 0x3fb8aa3b, v132
    v_lshlrev_b32 v134, 16, v38
    v_exp_f32 v132, v132
    v_lshlrev_b32 v135, 16, v39
    v_mul_f32 v133, v133, v44
    v_cvt_pk_bf16_f32 v132, v132, v132
    v_mul_f32 v134, v134, v44
    v_lshlrev_b32 v132, 16, v132
    v_mul_f32 v135, v135, v44
    v_mul_f32 v132, v132, v44
    v_mul_f32 v133, 0.15915494, v133
    v_mul_f32 v132, 0xbfb8aa3b, v132
    v_add_f32 v134, v134, v134
    v_add_f32 v135, v135, v135
    v_mul_f32 v178, 1.0, v132
    v_mul_f32 v179, 1.0, v133
    v_exp_f32 v178, v178
    v_fract_f32 v179, v179
    v_mul_f32 v180, 0x43800000, v132
    v_cos_f32 v136, v179
    v_sin_f32 v137, v179
    v_mul_f32 v181, 0x43800000, v133
    v_mul_f32 v136, v136, v178
    v_mul_f32 v137, v137, v178
    v_exp_f32 v180, v180
    v_sub_f32 v138, 0, v137
    v_fract_f32 v181, v181
    v_mul_f32 v182, 0x41000000, v132
    v_cos_f32 v152, v181
    v_sin_f32 v153, v181
    v_mul_f32 v183, 0x41000000, v133
    v_mul_f32 v152, v152, v180
    v_mul_f32 v153, v153, v180
    v_exp_f32 v182, v182
    v_sub_f32 v154, 0, v153
    v_fract_f32 v183, v183
    v_mul_f32 v140, v136, v136
    v_cos_f32 v148, v183
    v_sin_f32 v149, v183
    v_mul_f32 v141, v136, v137
    v_mul_f32 v148, v148, v182
    v_mul_f32 v149, v149, v182
    v_fmac_f32 v140, v137, v138
    v_sub_f32 v150, 0, v149
    v_add_f32 v141, v141, v141
    v_mul_f32 v156, v148, v148
    v_sub_f32 v142, 0, v141
    v_mul_f32 v157, v148, v149
    v_fmac_f32 v156, v149, v150
    v_add_f32 v157, v157, v157
    v_mul_f32 v144, v140, v140
    v_sub_f32 v158, 0, v157
    v_mul_f32 v145, v140, v141
    v_fmac_f32 v144, v141, v142
    v_add_f32 v145, v145, v145
    v_sub_f32 v146, 0, v145
    s_waitcnt lgkmcnt(0)
    s_setprio 1
    v_mfma_f32_16x16x32_bf16 v[72:75], v[84:87], v[116:119], v[72:75]
    v_mfma_f32_16x16x32_bf16 v[80:83], v[100:103], v[116:119], v[80:83]
    v_mfma_f32_16x16x32_bf16 v[72:75], v[88:91], v[120:123], v[72:75]
    v_mfma_f32_16x16x32_bf16 v[80:83], v[104:107], v[120:123], v[80:83]
    v_mfma_f32_16x16x32_bf16 v[72:75], v[92:95], v[124:127], v[72:75]
    v_mfma_f32_16x16x32_bf16 v[80:83], v[108:111], v[124:127], v[80:83]
    v_mfma_f32_16x16x32_bf16 v[72:75], v[96:99], v[128:131], v[72:75]
    v_mfma_f32_16x16x32_bf16 v[80:83], v[112:115], v[128:131], v[80:83]
    s_setprio 0
    v_cvt_pk_bf16_f32 v184, v134, -v135
    v_mul_f32 v160, v134, v136
    v_mul_f32 v161, v134, v137
    v_fmac_f32 v160, v135, v138
    v_fmac_f32 v161, v135, v136
    v_mul_f32 v164, v134, v152
    v_mul_f32 v165, v134, v153
    v_fmac_f32 v164, v135, v154
    v_fmac_f32 v165, v135, v152
    v_cvt_pk_bf16_f32 v185, v160, -v161
    v_cvt_pk_bf16_f32 v186, v164, -v165
    ds_write2_b32 v48, v184, v185 offset0:0 offset1:68
    v_mul_f32 v162, v160, v136
    v_mul_f32 v163, v160, v137
    v_fmac_f32 v162, v161, v138
    v_fmac_f32 v163, v161, v136
    v_mul_f32 v168, v164, v140
    v_mul_f32 v169, v164, v141
    v_fmac_f32 v168, v165, v142
    v_fmac_f32 v169, v165, v140
    v_mul_f32 v166, v164, v152
    v_mul_f32 v167, v164, v153
    v_fmac_f32 v166, v165, v154
    v_fmac_f32 v167, v165, v152
    v_cvt_pk_bf16_f32 v187, v162, -v163
    v_cvt_pk_bf16_f32 v188, v168, -v169
    v_cvt_pk_bf16_f32 v189, v166, -v167
    s_barrier
    ds_write2_b32 v50, v186, v188 offset0:0 offset1:68
    v_mul_f32 v160, v162, v136
    v_mul_f32 v161, v162, v137
    v_fmac_f32 v160, v163, v138
    v_fmac_f32 v161, v163, v136
    v_mul_f32 v170, v168, v140
    v_mul_f32 v171, v168, v141
    v_fmac_f32 v170, v169, v142
    v_fmac_f32 v171, v169, v140
    v_mul_f32 v172, v166, v144
    v_mul_f32 v173, v166, v145
    v_fmac_f32 v172, v167, v146
    v_fmac_f32 v173, v167, v144
    v_mul_f32 v164, v166, v152
    v_mul_f32 v165, v166, v153
    v_fmac_f32 v164, v167, v154
    v_fmac_f32 v165, v167, v152
    v_cvt_pk_bf16_f32 v190, v160, -v161
    v_cvt_pk_bf16_f32 v191, v172, -v173
    ds_write2_b32 v48, v187, v190 offset0:136 offset1:204
    ds_write2_b32 v51, v189, v191 offset0:0 offset1:68
    v_cvt_pk_bf16_f32 v184, v170, -v171
    v_cvt_pk_bf16_f32 v185, v164, -v165
    v_mul_f32 v162, v160, v136
    v_mul_f32 v163, v160, v137
    v_fmac_f32 v162, v161, v138
    v_fmac_f32 v163, v161, v136
    v_mul_f32 v168, v170, v140
    v_mul_f32 v169, v170, v141
    v_fmac_f32 v168, v171, v142
    v_fmac_f32 v169, v171, v140
    v_mul_f32 v174, v164, v144
    v_mul_f32 v175, v164, v145
    v_fmac_f32 v174, v165, v146
    v_fmac_f32 v175, v165, v144
    v_mul_f32 v166, v164, v152
    v_mul_f32 v167, v164, v153
    v_fmac_f32 v166, v165, v154
    v_fmac_f32 v167, v165, v152
    v_cvt_pk_bf16_f32 v186, v168, -v169
    v_cvt_pk_bf16_f32 v187, v174, -v175
    ds_write2_b32 v50, v184, v186 offset0:136 offset1:204
    ds_write2_b32 v51, v185, v187 offset0:136 offset1:204
    v_cvt_pk_bf16_f32 v188, v162, -v163
    v_cvt_pk_bf16_f32 v189, v166, -v167
    v_mul_f32 v160, v162, v136
    v_mul_f32 v161, v162, v137
    v_fmac_f32 v160, v163, v138
    v_fmac_f32 v161, v163, v136
    v_mul_f32 v164, v166, v152
    v_mul_f32 v165, v166, v153
    v_fmac_f32 v164, v167, v154
    v_fmac_f32 v165, v167, v152
    v_cvt_pk_bf16_f32 v190, v160, -v161
    v_cvt_pk_bf16_f32 v191, v164, -v165
    ds_write2_b32 v49, v188, v190 offset0:0 offset1:68
    ds_write2_b32 v52, v189, v191 offset0:0 offset1:68
    v_mul_f32 v162, v160, v136
    v_mul_f32 v163, v160, v137
    v_fmac_f32 v162, v161, v138
    v_fmac_f32 v163, v161, v136
    v_mul_f32 v166, v164, v152
    v_mul_f32 v167, v164, v153
    v_fmac_f32 v166, v165, v154
    v_fmac_f32 v167, v165, v152
    v_cvt_pk_bf16_f32 v184, v162, -v163
    v_cvt_pk_bf16_f32 v185, v166, -v167
    v_mul_f32 v160, v162, v136
    v_mul_f32 v161, v162, v137
    v_fmac_f32 v160, v163, v138
    v_fmac_f32 v161, v163, v136
    v_mul_f32 v164, v166, v152
    v_mul_f32 v165, v166, v153
    v_fmac_f32 v164, v167, v154
    v_fmac_f32 v165, v167, v152
    v_cvt_pk_bf16_f32 v186, v160, -v161
    v_cvt_pk_bf16_f32 v187, v164, -v165
    ds_write2_b32 v49, v184, v186 offset0:136 offset1:204
    ds_write2_b32 v52, v185, v187 offset0:136 offset1:204
    v_mul_f32 v166, v164, v152
    v_mul_f32 v167, v164, v153
    v_fmac_f32 v166, v165, v154
    v_fmac_f32 v167, v165, v152
    v_mov_b32 v189, 0x3f80
    v_cvt_pk_bf16_f32 v188, v166, -v167
    v_cvt_pk_bf16_f32 v190, v148, v149
    ds_write_b32 v53, v188 offset:0
    ds_read_b128 v[84:87], v56 offset:0
    s_barrier
    ds_read_b128 v[88:91], v56 offset:64
    ds_read_b128 v[92:95], v56 offset:128
    ds_read_b128 v[96:99], v56 offset:192
    ds_read_b128 v[100:103], v56 offset:4352
    ds_read_b128 v[104:107], v56 offset:4416
    ds_read_b128 v[108:111], v56 offset:4480
    ds_read_b128 v[112:115], v56 offset:4544
    ds_write2_b32 v48, v189, v190 offset0:0 offset1:68
    v_mul_f32 v168, v148, v156
    v_mul_f32 v169, v148, v157
    v_fmac_f32 v168, v149, v158
    v_fmac_f32 v169, v149, v156
    v_cvt_pk_bf16_f32 v191, v156, v157
    v_cvt_pk_bf16_f32 v184, v168, v169
    v_mul_f32 v160, v156, v156
    ds_write2_b32 v48, v191, v184 offset0:136 offset1:204
    v_mul_f32 v161, v156, v157
    v_fmac_f32 v160, v157, v158
    v_fmac_f32 v161, v157, v156
    v_mul_f32 v170, v168, v156
    v_mul_f32 v171, v168, v157
    v_fmac_f32 v170, v169, v158
    v_fmac_f32 v171, v169, v156
    v_cvt_pk_bf16_f32 v185, v160, v161
    v_cvt_pk_bf16_f32 v186, v170, v171
    v_mul_f32 v162, v160, v156
    ds_write2_b32 v49, v185, v186 offset0:0 offset1:68
    v_mul_f32 v163, v160, v157
    v_fmac_f32 v162, v161, v158
    v_fmac_f32 v163, v161, v156
    v_mul_f32 v168, v170, v156
    v_mul_f32 v169, v170, v157
    v_fmac_f32 v168, v171, v158
    v_fmac_f32 v169, v171, v156
    v_cvt_pk_bf16_f32 v187, v162, v163
    v_cvt_pk_bf16_f32 v188, v168, v169
    v_mul_f32 v160, v162, v156
    ds_write2_b32 v49, v187, v188 offset0:136 offset1:204
    v_mul_f32 v161, v162, v157
    v_fmac_f32 v160, v163, v158
    v_fmac_f32 v161, v163, v156
    v_mul_f32 v170, v168, v156
    v_mul_f32 v171, v168, v157
    v_fmac_f32 v170, v169, v158
    v_fmac_f32 v171, v169, v156
    v_cvt_pk_bf16_f32 v189, v160, v161
    v_cvt_pk_bf16_f32 v190, v170, v171
    v_mul_f32 v162, v160, v156
    ds_write2_b32 v50, v189, v190 offset0:0 offset1:68
    v_mul_f32 v163, v160, v157
    v_fmac_f32 v162, v161, v158
    v_fmac_f32 v163, v161, v156
    v_mul_f32 v168, v170, v156
    v_mul_f32 v169, v170, v157
    v_fmac_f32 v168, v171, v158
    v_fmac_f32 v169, v171, v156
    v_cvt_pk_bf16_f32 v191, v162, v163
    v_cvt_pk_bf16_f32 v184, v168, v169
    v_mul_f32 v160, v162, v156
    ds_write2_b32 v50, v191, v184 offset0:136 offset1:204
    v_mul_f32 v161, v162, v157
    v_fmac_f32 v160, v163, v158
    v_fmac_f32 v161, v163, v156
    v_mul_f32 v170, v168, v156
    v_mul_f32 v171, v168, v157
    v_fmac_f32 v170, v169, v158
    v_fmac_f32 v171, v169, v156
    v_cvt_pk_bf16_f32 v185, v160, v161
    v_cvt_pk_bf16_f32 v186, v170, v171
    v_mul_f32 v162, v160, v156
    ds_write2_b32 v51, v185, v186 offset0:0 offset1:68
    v_mul_f32 v163, v160, v157
    v_fmac_f32 v162, v161, v158
    v_fmac_f32 v163, v161, v156
    v_mul_f32 v168, v170, v156
    v_mul_f32 v169, v170, v157
    v_fmac_f32 v168, v171, v158
    v_fmac_f32 v169, v171, v156
    v_cvt_pk_bf16_f32 v187, v162, v163
    v_cvt_pk_bf16_f32 v188, v168, v169
    v_mul_f32 v160, v162, v156
    ds_write2_b32 v51, v187, v188 offset0:136 offset1:204
    ds_read_b128 v[116:119], v56 offset:0
    ds_read_b128 v[120:123], v56 offset:64
    ds_read_b128 v[124:127], v56 offset:128
    ds_read_b128 v[128:131], v56 offset:192
    v_mul_f32 v161, v162, v157
    v_fmac_f32 v160, v163, v158
    v_fmac_f32 v161, v163, v156
    s_barrier
    v_mul_f32 v170, v168, v156
    v_mul_f32 v171, v168, v157
    v_fmac_f32 v170, v169, v158
    v_fmac_f32 v171, v169, v156
    v_cvt_pk_bf16_f32 v189, v160, v161
    v_cvt_pk_bf16_f32 v190, v170, v171
    v_mul_f32 v162, v160, v156
    ds_write2_b32 v48, v189, v190 offset0:0 offset1:68
    v_mul_f32 v163, v160, v157
    v_fmac_f32 v162, v161, v158
    v_fmac_f32 v163, v161, v156
    v_mul_f32 v168, v170, v156
    v_mul_f32 v169, v170, v157
    v_fmac_f32 v168, v171, v158
    v_fmac_f32 v169, v171, v156
    v_cvt_pk_bf16_f32 v191, v162, v163
    v_cvt_pk_bf16_f32 v184, v168, v169
    v_mul_f32 v160, v162, v156
    ds_write2_b32 v48, v191, v184 offset0:136 offset1:204
    v_mul_f32 v161, v162, v157
    v_fmac_f32 v160, v163, v158
    v_fmac_f32 v161, v163, v156
    v_mul_f32 v170, v168, v156
    v_mul_f32 v171, v168, v157
    v_fmac_f32 v170, v169, v158
    v_fmac_f32 v171, v169, v156
    v_cvt_pk_bf16_f32 v185, v160, v161
    v_cvt_pk_bf16_f32 v186, v170, v171
    v_mul_f32 v162, v160, v156
    ds_write2_b32 v49, v185, v186 offset0:0 offset1:68
    v_mul_f32 v163, v160, v157
    v_fmac_f32 v162, v161, v158
    v_fmac_f32 v163, v161, v156
    v_mul_f32 v168, v170, v156
    v_mul_f32 v169, v170, v157
    v_fmac_f32 v168, v171, v158
    v_fmac_f32 v169, v171, v156
    v_cvt_pk_bf16_f32 v187, v162, v163
    v_cvt_pk_bf16_f32 v188, v168, v169
    v_mul_f32 v160, v162, v156
    ds_write2_b32 v49, v187, v188 offset0:136 offset1:204
    v_mul_f32 v161, v162, v157
    v_fmac_f32 v160, v163, v158
    v_fmac_f32 v161, v163, v156
    v_mul_f32 v170, v168, v156
    v_mul_f32 v171, v168, v157
    v_fmac_f32 v170, v169, v158
    v_fmac_f32 v171, v169, v156
    v_cvt_pk_bf16_f32 v189, v160, v161
    v_cvt_pk_bf16_f32 v190, v170, v171
    v_mul_f32 v162, v160, v156
    ds_write2_b32 v50, v189, v190 offset0:0 offset1:68
    v_mul_f32 v163, v160, v157
    v_fmac_f32 v162, v161, v158
    v_fmac_f32 v163, v161, v156
    v_mul_f32 v168, v170, v156
    v_mul_f32 v169, v170, v157
    v_fmac_f32 v168, v171, v158
    v_fmac_f32 v169, v171, v156
    v_cvt_pk_bf16_f32 v191, v162, v163
    v_cvt_pk_bf16_f32 v184, v168, v169
    v_mul_f32 v160, v162, v156
    ds_write2_b32 v50, v191, v184 offset0:136 offset1:204
    v_mul_f32 v161, v162, v157
    v_fmac_f32 v160, v163, v158
    v_fmac_f32 v161, v163, v156
    v_mul_f32 v170, v168, v156
    v_mul_f32 v171, v168, v157
    v_fmac_f32 v170, v169, v158
    v_fmac_f32 v171, v169, v156
    v_cvt_pk_bf16_f32 v185, v160, v161
    v_cvt_pk_bf16_f32 v186, v170, v171
    v_mul_f32 v162, v160, v156
    ds_write2_b32 v51, v185, v186 offset0:0 offset1:68
    v_mul_f32 v163, v160, v157
    v_fmac_f32 v162, v161, v158
    v_fmac_f32 v163, v161, v156
    v_mul_f32 v168, v170, v156
    v_mul_f32 v169, v170, v157
    v_fmac_f32 v168, v171, v158
    v_fmac_f32 v169, v171, v156
    v_cvt_pk_bf16_f32 v187, v162, v163
    v_cvt_pk_bf16_f32 v188, v168, v169
    ds_write2_b32 v51, v187, v188 offset0:136 offset1:204
    s_waitcnt lgkmcnt(8)
    s_setprio 1
    v_mfma_f32_16x16x32_bf16 v[68:71], v[84:87], v[116:119], v[68:71]
    v_mfma_f32_16x16x32_bf16 v[76:79], v[100:103], v[116:119], v[76:79]
    v_mfma_f32_16x16x32_bf16 v[68:71], v[88:91], v[120:123], v[68:71]
    v_mfma_f32_16x16x32_bf16 v[76:79], v[104:107], v[120:123], v[76:79]
    v_mfma_f32_16x16x32_bf16 v[68:71], v[92:95], v[124:127], v[68:71]
    v_mfma_f32_16x16x32_bf16 v[76:79], v[108:111], v[124:127], v[76:79]
    v_mfma_f32_16x16x32_bf16 v[68:71], v[96:99], v[128:131], v[68:71]
    v_mfma_f32_16x16x32_bf16 v[76:79], v[112:115], v[128:131], v[76:79]
    s_setprio 0
    s_barrier
    v_lshlrev_b32 v26, 4, v11
    s_mov_b32 s31, 13828096
    buffer_load_dwordx4 v[20:23], v26, s[36:39], s31 offen sc1
    ds_read_b128 v[116:119], v56 offset:0
    ds_read_b128 v[120:123], v56 offset:64
    ds_read_b128 v[124:127], v56 offset:128
    ds_read_b128 v[128:131], v56 offset:192
    s_waitcnt lgkmcnt(0)
    s_setprio 1
    v_mfma_f32_16x16x32_bf16 v[72:75], v[84:87], v[116:119], v[72:75]
    v_mfma_f32_16x16x32_bf16 v[80:83], v[100:103], v[116:119], v[80:83]
    v_mfma_f32_16x16x32_bf16 v[72:75], v[88:91], v[120:123], v[72:75]
    v_mfma_f32_16x16x32_bf16 v[80:83], v[104:107], v[120:123], v[80:83]
    v_mfma_f32_16x16x32_bf16 v[72:75], v[92:95], v[124:127], v[72:75]
    v_mfma_f32_16x16x32_bf16 v[80:83], v[108:111], v[124:127], v[80:83]
    v_mfma_f32_16x16x32_bf16 v[72:75], v[96:99], v[128:131], v[72:75]
    v_mfma_f32_16x16x32_bf16 v[80:83], v[112:115], v[128:131], v[80:83]
    s_setprio 0
    s_add_u32 s73, s89, 16
    v_mov_b32 v28, s89
    v_mov_b32 v27, 0
    ds_write_b32 v28, v27 offset:12
    v_and_b32 v132, 15, v11
    v_lshrrev_b32 v133, 4, v11
    v_lshlrev_b32 v134, 3, v132
    v_cmp_eq_u32 vcc, 1, v133
    v_add_u32 v135, 4, v134
    v_mov_b32 v136, 128
    v_cndmask_b32 v134, v134, v135, vcc
    v_cmp_eq_u32 vcc, 2, v133
    v_lshlrev_b32 v135, 2, v132
    v_mov_b32 v137, 2
    v_add_u32 v135, 256, v135
    v_cndmask_b32 v136, v136, 64, vcc
    v_cndmask_b32 v134, v134, v135, vcc
    v_cmp_eq_u32 vcc, 3, v133
    v_lshlrev_b32 v135, 1, v132
    v_mov_b32 v139, 64
    v_add_u32 v135, 384, v135
    v_cndmask_b32 v136, v136, 32, vcc
    v_cndmask_b32 v134, v134, v135, vcc
    v_cndmask_b32 v137, v137, v139, vcc
    v_lshlrev_b32 v134, 2, v134
    v_lshlrev_b32 v140, 2, v132
    v_add_u32 v134, s73, v134
    v_add_u32 v140, s73, v140
    v_lshl_add_u32 v135, v137, 2, v134
    v_lshl_add_u32 v138, v136, 2, v134
    v_lshl_add_u32 v139, v136, 2, v135
    ds_write_b32 v134, v68
    ds_write_b32 v134, v69 offset:4
    ds_write_b32 v135, v70
    ds_write_b32 v135, v71 offset:4
    ds_write_b32 v138, v72
    ds_write_b32 v138, v73 offset:4
    ds_write_b32 v139, v74
    ds_write_b32 v139, v75 offset:4
    s_mov_b64 s[92:93], exec
    s_mov_b64 exec, 0xffff
    ds_write_b32 v140, v76 offset:2048
    ds_write_b32 v140, v77 offset:2176
    ds_write_b32 v140, v78 offset:2304
    ds_write_b32 v140, v79 offset:2432
    ds_write_b32 v140, v80 offset:2112
    ds_write_b32 v140, v81 offset:2240
    ds_write_b32 v140, v82 offset:2368
    ds_write_b32 v140, v83 offset:2496
    s_mov_b64 exec, 0x10000
    ds_write_b32 v140, v76 offset:2560
    s_mov_b64 exec, s[92:93]
    s_waitcnt lgkmcnt(0)
    s_barrier
    s_waitcnt vmcnt(0)
    s_mov_b32 s82, 0
Lspx:
    v_and_b32 v24, v20, v21
    v_and_b32 v25, v22, v23
    v_and_b32 v24, v24, v25
    v_cmp_eq_u32 vcc, 1, v24
    s_nop 1
    s_cmp_eq_u64 vcc, exec
    s_cbranch_scc1 Lspokx
    s_add_u32 s82, s82, 1
    s_cmp_gt_u32 s82, 1048576
    s_cbranch_scc1 Lmain_end
    s_sleep 3
    buffer_load_dwordx4 v[20:23], v26, s[36:39], s31 offen sc1
    s_waitcnt vmcnt(0)
    s_branch Lspx
Lspokx:
    s_mul_i32 s30, s24, 12864
    v_mul_u32_u24 v212, 10240, v11
    s_lshl_b32 s28, s88, 4
    s_add_u32 s28, s28, 6291456
    s_add_u32 s29, s28, 0
    buffer_load_dwordx4 v[196:199], v212, s[36:39], s29 offen sc1
    s_add_u32 s29, s28, 655360
    buffer_load_dwordx4 v[200:203], v212, s[36:39], s29 offen sc1
    s_add_u32 s29, s28, 1310720
    buffer_load_dwordx4 v[204:207], v212, s[36:39], s29 offen sc1
    s_add_u32 s29, s28, 1966080
    buffer_load_dwordx4 v[208:211], v212, s[36:39], s29 offen sc1
    s_barrier
    s_setprio 1
    s_waitcnt vmcnt(0)
    v_lshlrev_b32 v29, 16, v29
    s_nop 0
    v_readfirstlane_b32 s33, v29
    v_lshlrev_b32 v212, 4, v11
    v_add_u32 v212, s30, v212
    v_lshlrev_b32 v213, 3, v11
    v_add_u32 v213, s30, v213
    v_mov_b32 v214, 0
    v_mov_b32 v215, 0
    ds_write_b64 v213, v[214:215] offset:8256
    ds_write_b128 v212, v[196:199] offset:8768
    ds_write_b128 v212, v[200:203] offset:9792
    ds_write_b128 v212, v[204:207] offset:10816
    ds_write_b128 v212, v[208:211] offset:11840
    v_mov_b32 v121, v11
    v_and_b32 v122, 15, v121
    v_lshrrev_b32 v123, 4, v121
    v_lshlrev_b32 v124, 2, v122
    v_lshlrev_b32 v125, 5, v123
    v_sub_u32 v124, v124, v125
    s_add_u32 s28, s30, 104
    v_add_u32 v112, s28, v124
    v_add_u32 v113, 1024, v112
    v_add_u32 v114, 2048, v112
    v_add_u32 v115, 3072, v112
    v_add_u32 v116, 4096, v112
    v_add_u32 v117, 5120, v112
    v_add_u32 v118, 6144, v112
    v_add_u32 v119, 7168, v112
    v_lshlrev_b32 v124, 5, v122
    v_lshl_add_u32 v124, v123, 4, v124
    s_add_u32 s28, s30, 8288
    v_add_u32 v120, s28, v124
    s_waitcnt lgkmcnt(0)
    v_lshl_add_u32 v122, v121, 4, s73
    v_lshl_add_u32 v123, v121, 3, s73
    v_lshl_add_u32 v124, v121, 2, s73
    v_lshrrev_b32 v125, 1, v121
    v_lshl_add_u32 v125, v125, 2, s73
    v_lshlrev_b32 v126, 4, v121
    s_add_u32 s29, s30, 64
    v_add_u32 v126, s29, v126
    v_subrev_u32 v127, 4, v122
    v_mov_b32 v128, 0
    v_lshlrev_b32 v129, 2, v121
    v_add_u32 v129, s30, v129
    v_cmp_gt_u32 vcc, 16, v121
    s_and_saveexec_b64 s[92:93], vcc
    ds_write_b32 v129, v128 offset:0
    s_mov_b64 exec, s[92:93]
    ds_read_b128 v[32:35], v122
    ds_read_b32 v36, v127
    ds_read_b64 v[38:39], v123 offset:1024
    ds_read_b32 v40, v123 offset:1032
    ds_read_b32 v41, v124 offset:1020
    ds_read_b32 v42, v124 offset:1536
    ds_read_b32 v43, v124 offset:1540
    ds_read_b32 v44, v124 offset:1792
    ds_read_b32 v45, v124 offset:1796
    s_waitcnt lgkmcnt(4)
    ds_read_b32 v46, v125 offset:2048
    ds_read_b32 v47, v125 offset:2052
    ds_read_b32 v48, v125 offset:2176
    ds_read_b32 v49, v125 offset:2180
    ds_read_b32 v50, v125 offset:2304
    ds_read_b32 v51, v125 offset:2308
    ds_read_b32 v52, v125 offset:2432
    ds_read_b32 v53, v125 offset:2436
    v_and_b32 v128, 1, v121
    v_cmp_eq_u32 s[54:55], 1, v128
    v_and_b32 v128, 3, v121
    v_cmp_eq_u32 s[56:57], 3, v128
    v_cmp_eq_u32 s[52:53], 0, v121
    s_waitcnt lgkmcnt(0)
    v_cvt_pk_bf16_f32 v56, v32, v36
    v_cvt_pk_bf16_f32 v57, v33, v32
    v_cvt_pk_bf16_f32 v58, v34, v33
    v_cvt_pk_bf16_f32 v59, v35, v34
    ds_write_b128 v126, v[56:59] offset:0
    v_cndmask_b32 v37, v38, v41, s[52:53]
    v_cvt_pk_bf16_f32 v61, v38, v38
    v_cvt_pk_bf16_f32 v62, v39, v38
    v_cvt_pk_bf16_f32 v63, v40, v39
    v_cvt_pk_bf16_f32 v60, v38, v37
    ds_write_b128 v126, v[60:63] offset:1024
    v_cndmask_b32 v37, v42, v43, s[54:55]
    v_cvt_pk_bf16_f32 v64, v42, v42
    v_mov_b32 v65, v64
    v_cvt_pk_bf16_f32 v66, v37, v42
    v_cvt_pk_bf16_f32 v67, v43, v37
    ds_write_b128 v126, v[64:67] offset:2048
    v_cndmask_b32 v37, v44, v45, s[54:55]
    v_cvt_pk_bf16_f32 v68, v44, v44
    v_mov_b32 v69, v68
    v_cvt_pk_bf16_f32 v70, v37, v44
    v_cvt_pk_bf16_f32 v71, v45, v37
    ds_write_b128 v126, v[68:71] offset:3072
    v_cndmask_b32 v36, v46, v47, s[56:57]
    v_cndmask_b32 v37, v46, v47, s[54:55]
    v_cvt_pk_bf16_f32 v72, v36, v46
    v_cvt_pk_bf16_f32 v73, v37, v36
    v_cvt_pk_bf16_f32 v74, v37, v37
    v_mov_b32 v75, v74
    ds_write_b128 v126, v[72:75] offset:4096
    v_cndmask_b32 v36, v48, v49, s[56:57]
    v_cndmask_b32 v37, v48, v49, s[54:55]
    v_cvt_pk_bf16_f32 v76, v36, v48
    v_cvt_pk_bf16_f32 v77, v37, v36
    v_cvt_pk_bf16_f32 v78, v37, v37
    v_mov_b32 v79, v78
    ds_write_b128 v126, v[76:79] offset:5120
    v_cndmask_b32 v36, v50, v51, s[56:57]
    v_cndmask_b32 v37, v50, v51, s[54:55]
    v_cvt_pk_bf16_f32 v72, v36, v50
    v_cvt_pk_bf16_f32 v73, v37, v36
    v_cvt_pk_bf16_f32 v74, v37, v37
    v_mov_b32 v75, v74
    ds_write_b128 v126, v[72:75] offset:6144
    v_cndmask_b32 v36, v52, v53, s[56:57]
    v_cndmask_b32 v37, v52, v53, s[54:55]
    v_cvt_pk_bf16_f32 v76, v36, v52
    v_cvt_pk_bf16_f32 v77, v37, v36
    v_cvt_pk_bf16_f32 v78, v37, v37
    v_mov_b32 v79, v78
    ds_write_b128 v126, v[76:79] offset:7168
    s_waitcnt lgkmcnt(0)
    s_setprio 0
    v_mov_b32 v122, 154372
    s_mov_b32 s34, 0
Lcw:
    ds_read_b32 v123, v122
    s_waitcnt lgkmcnt(0)
    v_readfirstlane_b32 s28, v123
    s_add_u32 s34, s34, 1
    s_cmp_gt_u32 s34, 8388608
    s_cbranch_scc1 Lmain_end
    s_cmp_eq_u32 s28, 4
    s_cbranch_scc1 Lcwok
    s_sleep 1
    s_branch Lcw
Lcwok:
    s_setprio 1
    v_mov_b32 v0, 0
    v_mov_b32 v1, 0
    v_mov_b32 v2, 0
    v_mov_b32 v3, 0
    v_mov_b32 v4, 0
    v_mov_b32 v5, 0
    v_mov_b32 v6, 0
    v_mov_b32 v7, 0
    v_mov_b32 v8, 0
    v_mov_b32 v9, 0
    v_mov_b32 v10, 0
    v_mov_b32 v11, 0
    v_mov_b32 v12, 0
    v_mov_b32 v13, 0
    v_mov_b32 v14, 0
    v_mov_b32 v15, 0
    v_mov_b32 v16, 0
    v_mov_b32 v17, 0
    v_mov_b32 v18, 0
    v_mov_b32 v19, 0
    v_mov_b32 v20, 0
    v_mov_b32 v21, 0
    v_mov_b32 v22, 0
    v_mov_b32 v23, 0
    v_mov_b32 v24, 0
    v_mov_b32 v25, 0
    v_mov_b32 v26, 0
    v_mov_b32 v27, 0
    v_mov_b32 v28, 0
    v_mov_b32 v29, 0
    v_mov_b32 v30, 0
    v_mov_b32 v31, 0
    ds_read_b128 v[32:35], v120 offset:448
    ds_read_b128 v[36:39], v120 offset:960
    ds_read_b128 v[40:43], v120 offset:1472
    ds_read_b128 v[44:47], v120 offset:1984
    ds_read_b128 v[48:51], v120 offset:2496
    ds_read_b128 v[52:55], v120 offset:3008
    ds_read_b128 v[56:59], v120 offset:3520
    ds_read_b128 v[60:63], v120 offset:4032
    ds_read2_b32 v[96:97], v112 offset0:6 offset1:4
    ds_read2_b32 v[98:99], v112 offset0:2 offset1:0
    ds_read2_b32 v[100:101], v113 offset0:6 offset1:4
    ds_read2_b32 v[102:103], v113 offset0:2 offset1:0
    ds_read2_b32 v[104:105], v114 offset0:6 offset1:4
    ds_read2_b32 v[106:107], v114 offset0:2 offset1:0
    s_waitcnt lgkmcnt(4)
    v_mfma_f32_16x16x32_bf16 v[0:3], v[96:99], v[32:35], v[0:3]
    v_mfma_f32_16x16x32_bf16 v[4:7], v[96:99], v[36:39], v[4:7]
    ds_read2_b32 v[108:109], v115 offset0:6 offset1:4
    v_mfma_f32_16x16x32_bf16 v[8:11], v[96:99], v[40:43], v[8:11]
    v_mfma_f32_16x16x32_bf16 v[12:15], v[96:99], v[44:47], v[12:15]
    ds_read2_b32 v[110:111], v115 offset0:2 offset1:0
    v_mfma_f32_16x16x32_bf16 v[16:19], v[96:99], v[48:51], v[16:19]
    v_mfma_f32_16x16x32_bf16 v[20:23], v[96:99], v[52:55], v[20:23]
    ds_read_b128 v[64:67], v120 offset:384
    v_mfma_f32_16x16x32_bf16 v[24:27], v[96:99], v[56:59], v[24:27]
    v_mfma_f32_16x16x32_bf16 v[28:31], v[96:99], v[60:63], v[28:31]
    ds_read_b128 v[68:71], v120 offset:896
    s_waitcnt lgkmcnt(6)
    v_mfma_f32_16x16x32_bf16 v[4:7], v[100:103], v[32:35], v[4:7]
    v_mfma_f32_16x16x32_bf16 v[8:11], v[100:103], v[36:39], v[8:11]
    ds_read2_b32 v[96:97], v116 offset0:6 offset1:4
    v_mfma_f32_16x16x32_bf16 v[12:15], v[100:103], v[40:43], v[12:15]
    v_mfma_f32_16x16x32_bf16 v[16:19], v[100:103], v[44:47], v[16:19]
    ds_read2_b32 v[98:99], v116 offset0:2 offset1:0
    v_mfma_f32_16x16x32_bf16 v[20:23], v[100:103], v[48:51], v[20:23]
    v_mfma_f32_16x16x32_bf16 v[24:27], v[100:103], v[52:55], v[24:27]
    ds_read_b128 v[72:75], v120 offset:1408
    v_mfma_f32_16x16x32_bf16 v[28:31], v[100:103], v[56:59], v[28:31]
    ds_read_b128 v[76:79], v120 offset:1920
    s_waitcnt lgkmcnt(8)
    v_mfma_f32_16x16x32_bf16 v[8:11], v[104:107], v[32:35], v[8:11]
    v_mfma_f32_16x16x32_bf16 v[12:15], v[104:107], v[36:39], v[12:15]
    ds_read2_b32 v[100:101], v117 offset0:6 offset1:4
    v_mfma_f32_16x16x32_bf16 v[16:19], v[104:107], v[40:43], v[16:19]
    ds_read2_b32 v[102:103], v117 offset0:2 offset1:0
    v_mfma_f32_16x16x32_bf16 v[20:23], v[104:107], v[44:47], v[20:23]
    v_mfma_f32_16x16x32_bf16 v[24:27], v[104:107], v[48:51], v[24:27]
    ds_read_b128 v[80:83], v120 offset:2432
    v_mfma_f32_16x16x32_bf16 v[28:31], v[104:107], v[52:55], v[28:31]
    ds_read_b128 v[84:87], v120 offset:2944
    s_waitcnt lgkmcnt(10)
    v_mfma_f32_16x16x32_bf16 v[12:15], v[108:111], v[32:35], v[12:15]
    v_mfma_f32_16x16x32_bf16 v[16:19], v[108:111], v[36:39], v[16:19]
    ds_read2_b32 v[104:105], v118 offset0:6 offset1:4
    v_mfma_f32_16x16x32_bf16 v[20:23], v[108:111], v[40:43], v[20:23]
    ds_read2_b32 v[106:107], v118 offset0:2 offset1:0
    v_mfma_f32_16x16x32_bf16 v[24:27], v[108:111], v[44:47], v[24:27]
    ds_read_b128 v[88:91], v120 offset:3456
    v_mfma_f32_16x16x32_bf16 v[28:31], v[108:111], v[48:51], v[28:31]
    ds_read_b128 v[92:95], v120 offset:3968
    s_waitcnt lgkmcnt(10)
    v_mfma_f32_16x16x32_bf16 v[16:19], v[96:99], v[32:35], v[16:19]
    v_mfma_f32_16x16x32_bf16 v[20:23], v[96:99], v[36:39], v[20:23]
    ds_read2_b32 v[108:109], v119 offset0:6 offset1:4
    v_mfma_f32_16x16x32_bf16 v[24:27], v[96:99], v[40:43], v[24:27]
    v_mfma_f32_16x16x32_bf16 v[28:31], v[96:99], v[44:47], v[28:31]
    ds_read2_b32 v[110:111], v119 offset0:2 offset1:0
    s_waitcnt lgkmcnt(8)
    v_mfma_f32_16x16x32_bf16 v[20:23], v[100:103], v[32:35], v[20:23]
    v_mfma_f32_16x16x32_bf16 v[24:27], v[100:103], v[36:39], v[24:27]
    ds_read2_b32 v[96:97], v112 offset0:38 offset1:36
    v_mfma_f32_16x16x32_bf16 v[28:31], v[100:103], v[40:43], v[28:31]
    ds_read2_b32 v[98:99], v112 offset0:34 offset1:32
    s_waitcnt lgkmcnt(6)
    v_mfma_f32_16x16x32_bf16 v[24:27], v[104:107], v[32:35], v[24:27]
    ds_read2_b32 v[100:101], v113 offset0:38 offset1:36
    v_mfma_f32_16x16x32_bf16 v[28:31], v[104:107], v[36:39], v[28:31]
    ds_read2_b32 v[102:103], v113 offset0:34 offset1:32
    s_waitcnt lgkmcnt(4)
    v_mfma_f32_16x16x32_bf16 v[28:31], v[108:111], v[32:35], v[28:31]
    ds_read2_b32 v[104:105], v114 offset0:38 offset1:36
    ds_read2_b32 v[106:107], v114 offset0:34 offset1:32
    s_waitcnt lgkmcnt(4)
    s_waitcnt lgkmcnt(8)
    v_mfma_f32_16x16x32_bf16 v[0:3], v[96:99], v[64:67], v[0:3]
    v_mfma_f32_16x16x32_bf16 v[4:7], v[96:99], v[68:71], v[4:7]
    ds_read2_b32 v[108:109], v115 offset0:38 offset1:36
    v_mfma_f32_16x16x32_bf16 v[8:11], v[96:99], v[72:75], v[8:11]
    v_mfma_f32_16x16x32_bf16 v[12:15], v[96:99], v[76:79], v[12:15]
    ds_read2_b32 v[110:111], v115 offset0:34 offset1:32
    v_mfma_f32_16x16x32_bf16 v[16:19], v[96:99], v[80:83], v[16:19]
    v_mfma_f32_16x16x32_bf16 v[20:23], v[96:99], v[84:87], v[20:23]
    ds_read_b128 v[32:35], v120 offset:320
    v_mfma_f32_16x16x32_bf16 v[24:27], v[96:99], v[88:91], v[24:27]
    v_mfma_f32_16x16x32_bf16 v[28:31], v[96:99], v[92:95], v[28:31]
    ds_read_b128 v[36:39], v120 offset:832
    s_waitcnt lgkmcnt(6)
    v_mfma_f32_16x16x32_bf16 v[4:7], v[100:103], v[64:67], v[4:7]
    v_mfma_f32_16x16x32_bf16 v[8:11], v[100:103], v[68:71], v[8:11]
    ds_read2_b32 v[96:97], v116 offset0:38 offset1:36
    v_mfma_f32_16x16x32_bf16 v[12:15], v[100:103], v[72:75], v[12:15]
    v_mfma_f32_16x16x32_bf16 v[16:19], v[100:103], v[76:79], v[16:19]
    ds_read2_b32 v[98:99], v116 offset0:34 offset1:32
    v_mfma_f32_16x16x32_bf16 v[20:23], v[100:103], v[80:83], v[20:23]
    v_mfma_f32_16x16x32_bf16 v[24:27], v[100:103], v[84:87], v[24:27]
    ds_read_b128 v[40:43], v120 offset:1344
    v_mfma_f32_16x16x32_bf16 v[28:31], v[100:103], v[88:91], v[28:31]
    ds_read_b128 v[44:47], v120 offset:1856
    s_waitcnt lgkmcnt(8)
    v_mfma_f32_16x16x32_bf16 v[8:11], v[104:107], v[64:67], v[8:11]
    v_mfma_f32_16x16x32_bf16 v[12:15], v[104:107], v[68:71], v[12:15]
    ds_read2_b32 v[100:101], v117 offset0:38 offset1:36
    v_mfma_f32_16x16x32_bf16 v[16:19], v[104:107], v[72:75], v[16:19]
    ds_read2_b32 v[102:103], v117 offset0:34 offset1:32
    v_mfma_f32_16x16x32_bf16 v[20:23], v[104:107], v[76:79], v[20:23]
    v_mfma_f32_16x16x32_bf16 v[24:27], v[104:107], v[80:83], v[24:27]
    ds_read_b128 v[48:51], v120 offset:2368
    v_mfma_f32_16x16x32_bf16 v[28:31], v[104:107], v[84:87], v[28:31]
    ds_read_b128 v[52:55], v120 offset:2880
    s_waitcnt lgkmcnt(10)
    v_mfma_f32_16x16x32_bf16 v[12:15], v[108:111], v[64:67], v[12:15]
    v_mfma_f32_16x16x32_bf16 v[16:19], v[108:111], v[68:71], v[16:19]
    ds_read2_b32 v[104:105], v118 offset0:38 offset1:36
    v_mfma_f32_16x16x32_bf16 v[20:23], v[108:111], v[72:75], v[20:23]
    ds_read2_b32 v[106:107], v118 offset0:34 offset1:32
    v_mfma_f32_16x16x32_bf16 v[24:27], v[108:111], v[76:79], v[24:27]
    ds_read_b128 v[56:59], v120 offset:3392
    v_mfma_f32_16x16x32_bf16 v[28:31], v[108:111], v[80:83], v[28:31]
    ds_read_b128 v[60:63], v120 offset:3904
    s_waitcnt lgkmcnt(10)
    v_mfma_f32_16x16x32_bf16 v[16:19], v[96:99], v[64:67], v[16:19]
    v_mfma_f32_16x16x32_bf16 v[20:23], v[96:99], v[68:71], v[20:23]
    ds_read2_b32 v[108:109], v119 offset0:38 offset1:36
    v_mfma_f32_16x16x32_bf16 v[24:27], v[96:99], v[72:75], v[24:27]
    v_mfma_f32_16x16x32_bf16 v[28:31], v[96:99], v[76:79], v[28:31]
    ds_read2_b32 v[110:111], v119 offset0:34 offset1:32
    s_waitcnt lgkmcnt(8)
    v_mfma_f32_16x16x32_bf16 v[20:23], v[100:103], v[64:67], v[20:23]
    v_mfma_f32_16x16x32_bf16 v[24:27], v[100:103], v[68:71], v[24:27]
    ds_read2_b32 v[96:97], v112 offset0:70 offset1:68
    v_mfma_f32_16x16x32_bf16 v[28:31], v[100:103], v[72:75], v[28:31]
    ds_read2_b32 v[98:99], v112 offset0:66 offset1:64
    s_waitcnt lgkmcnt(6)
    v_mfma_f32_16x16x32_bf16 v[24:27], v[104:107], v[64:67], v[24:27]
    ds_read2_b32 v[100:101], v113 offset0:70 offset1:68
    v_mfma_f32_16x16x32_bf16 v[28:31], v[104:107], v[68:71], v[28:31]
    ds_read2_b32 v[102:103], v113 offset0:66 offset1:64
    s_waitcnt lgkmcnt(4)
    v_mfma_f32_16x16x32_bf16 v[28:31], v[108:111], v[64:67], v[28:31]
    ds_read2_b32 v[104:105], v114 offset0:70 offset1:68
    ds_read2_b32 v[106:107], v114 offset0:66 offset1:64
    s_waitcnt lgkmcnt(4)
    s_waitcnt lgkmcnt(8)
    v_mfma_f32_16x16x32_bf16 v[0:3], v[96:99], v[32:35], v[0:3]
    v_mfma_f32_16x16x32_bf16 v[4:7], v[96:99], v[36:39], v[4:7]
    ds_read2_b32 v[108:109], v115 offset0:70 offset1:68
    v_mfma_f32_16x16x32_bf16 v[8:11], v[96:99], v[40:43], v[8:11]
    v_mfma_f32_16x16x32_bf16 v[12:15], v[96:99], v[44:47], v[12:15]
    ds_read2_b32 v[110:111], v115 offset0:66 offset1:64
    v_mfma_f32_16x16x32_bf16 v[16:19], v[96:99], v[48:51], v[16:19]
    v_mfma_f32_16x16x32_bf16 v[20:23], v[96:99], v[52:55], v[20:23]
    ds_read_b128 v[64:67], v120 offset:256
    v_mfma_f32_16x16x32_bf16 v[24:27], v[96:99], v[56:59], v[24:27]
    v_mfma_f32_16x16x32_bf16 v[28:31], v[96:99], v[60:63], v[28:31]
    ds_read_b128 v[68:71], v120 offset:768
    s_waitcnt lgkmcnt(6)
    v_mfma_f32_16x16x32_bf16 v[4:7], v[100:103], v[32:35], v[4:7]
    v_mfma_f32_16x16x32_bf16 v[8:11], v[100:103], v[36:39], v[8:11]
    ds_read2_b32 v[96:97], v116 offset0:70 offset1:68
    v_mfma_f32_16x16x32_bf16 v[12:15], v[100:103], v[40:43], v[12:15]
    v_mfma_f32_16x16x32_bf16 v[16:19], v[100:103], v[44:47], v[16:19]
    ds_read2_b32 v[98:99], v116 offset0:66 offset1:64
    v_mfma_f32_16x16x32_bf16 v[20:23], v[100:103], v[48:51], v[20:23]
    v_mfma_f32_16x16x32_bf16 v[24:27], v[100:103], v[52:55], v[24:27]
    ds_read_b128 v[72:75], v120 offset:1280
    v_mfma_f32_16x16x32_bf16 v[28:31], v[100:103], v[56:59], v[28:31]
    ds_read_b128 v[76:79], v120 offset:1792
    s_waitcnt lgkmcnt(8)
    v_mfma_f32_16x16x32_bf16 v[8:11], v[104:107], v[32:35], v[8:11]
    v_mfma_f32_16x16x32_bf16 v[12:15], v[104:107], v[36:39], v[12:15]
    ds_read2_b32 v[100:101], v117 offset0:70 offset1:68
    v_mfma_f32_16x16x32_bf16 v[16:19], v[104:107], v[40:43], v[16:19]
    ds_read2_b32 v[102:103], v117 offset0:66 offset1:64
    v_mfma_f32_16x16x32_bf16 v[20:23], v[104:107], v[44:47], v[20:23]
    v_mfma_f32_16x16x32_bf16 v[24:27], v[104:107], v[48:51], v[24:27]
    ds_read_b128 v[80:83], v120 offset:2304
    v_mfma_f32_16x16x32_bf16 v[28:31], v[104:107], v[52:55], v[28:31]
    ds_read_b128 v[84:87], v120 offset:2816
    s_waitcnt lgkmcnt(10)
    v_mfma_f32_16x16x32_bf16 v[12:15], v[108:111], v[32:35], v[12:15]
    v_mfma_f32_16x16x32_bf16 v[16:19], v[108:111], v[36:39], v[16:19]
    ds_read2_b32 v[104:105], v118 offset0:70 offset1:68
    v_mfma_f32_16x16x32_bf16 v[20:23], v[108:111], v[40:43], v[20:23]
    ds_read2_b32 v[106:107], v118 offset0:66 offset1:64
    v_mfma_f32_16x16x32_bf16 v[24:27], v[108:111], v[44:47], v[24:27]
    ds_read_b128 v[88:91], v120 offset:3328
    v_mfma_f32_16x16x32_bf16 v[28:31], v[108:111], v[48:51], v[28:31]
    ds_read_b128 v[92:95], v120 offset:3840
    s_waitcnt lgkmcnt(10)
    v_mfma_f32_16x16x32_bf16 v[16:19], v[96:99], v[32:35], v[16:19]
    v_mfma_f32_16x16x32_bf16 v[20:23], v[96:99], v[36:39], v[20:23]
    ds_read2_b32 v[108:109], v119 offset0:70 offset1:68
    v_mfma_f32_16x16x32_bf16 v[24:27], v[96:99], v[40:43], v[24:27]
    v_mfma_f32_16x16x32_bf16 v[28:31], v[96:99], v[44:47], v[28:31]
    ds_read2_b32 v[110:111], v119 offset0:66 offset1:64
    s_waitcnt lgkmcnt(8)
    v_mfma_f32_16x16x32_bf16 v[20:23], v[100:103], v[32:35], v[20:23]
    v_mfma_f32_16x16x32_bf16 v[24:27], v[100:103], v[36:39], v[24:27]
    ds_read2_b32 v[96:97], v112 offset0:102 offset1:100
    v_mfma_f32_16x16x32_bf16 v[28:31], v[100:103], v[40:43], v[28:31]
    ds_read2_b32 v[98:99], v112 offset0:98 offset1:96
    s_waitcnt lgkmcnt(6)
    v_mfma_f32_16x16x32_bf16 v[24:27], v[104:107], v[32:35], v[24:27]
    ds_read2_b32 v[100:101], v113 offset0:102 offset1:100
    v_mfma_f32_16x16x32_bf16 v[28:31], v[104:107], v[36:39], v[28:31]
    ds_read2_b32 v[102:103], v113 offset0:98 offset1:96
    s_waitcnt lgkmcnt(4)
    v_mfma_f32_16x16x32_bf16 v[28:31], v[108:111], v[32:35], v[28:31]
    ds_read2_b32 v[104:105], v114 offset0:102 offset1:100
    ds_read2_b32 v[106:107], v114 offset0:98 offset1:96
    s_waitcnt lgkmcnt(4)
    s_waitcnt lgkmcnt(8)
    v_mfma_f32_16x16x32_bf16 v[0:3], v[96:99], v[64:67], v[0:3]
    v_mfma_f32_16x16x32_bf16 v[4:7], v[96:99], v[68:71], v[4:7]
    ds_read2_b32 v[108:109], v115 offset0:102 offset1:100
    v_mfma_f32_16x16x32_bf16 v[8:11], v[96:99], v[72:75], v[8:11]
    v_mfma_f32_16x16x32_bf16 v[12:15], v[96:99], v[76:79], v[12:15]
    ds_read2_b32 v[110:111], v115 offset0:98 offset1:96
    v_mfma_f32_16x16x32_bf16 v[16:19], v[96:99], v[80:83], v[16:19]
    v_mfma_f32_16x16x32_bf16 v[20:23], v[96:99], v[84:87], v[20:23]
    ds_read_b128 v[32:35], v120 offset:192
    v_mfma_f32_16x16x32_bf16 v[24:27], v[96:99], v[88:91], v[24:27]
    v_mfma_f32_16x16x32_bf16 v[28:31], v[96:99], v[92:95], v[28:31]
    ds_read_b128 v[36:39], v120 offset:704
    s_waitcnt lgkmcnt(6)
    v_mfma_f32_16x16x32_bf16 v[4:7], v[100:103], v[64:67], v[4:7]
    v_mfma_f32_16x16x32_bf16 v[8:11], v[100:103], v[68:71], v[8:11]
    ds_read2_b32 v[96:97], v116 offset0:102 offset1:100
    v_mfma_f32_16x16x32_bf16 v[12:15], v[100:103], v[72:75], v[12:15]
    v_mfma_f32_16x16x32_bf16 v[16:19], v[100:103], v[76:79], v[16:19]
    ds_read2_b32 v[98:99], v116 offset0:98 offset1:96
    v_mfma_f32_16x16x32_bf16 v[20:23], v[100:103], v[80:83], v[20:23]
    v_mfma_f32_16x16x32_bf16 v[24:27], v[100:103], v[84:87], v[24:27]
    ds_read_b128 v[40:43], v120 offset:1216
    v_mfma_f32_16x16x32_bf16 v[28:31], v[100:103], v[88:91], v[28:31]
    ds_read_b128 v[44:47], v120 offset:1728
    s_waitcnt lgkmcnt(8)
    v_mfma_f32_16x16x32_bf16 v[8:11], v[104:107], v[64:67], v[8:11]
    v_mfma_f32_16x16x32_bf16 v[12:15], v[104:107], v[68:71], v[12:15]
    ds_read2_b32 v[100:101], v117 offset0:102 offset1:100
    v_mfma_f32_16x16x32_bf16 v[16:19], v[104:107], v[72:75], v[16:19]
    ds_read2_b32 v[102:103], v117 offset0:98 offset1:96
    v_mfma_f32_16x16x32_bf16 v[20:23], v[104:107], v[76:79], v[20:23]
    v_mfma_f32_16x16x32_bf16 v[24:27], v[104:107], v[80:83], v[24:27]
    ds_read_b128 v[48:51], v120 offset:2240
    v_mfma_f32_16x16x32_bf16 v[28:31], v[104:107], v[84:87], v[28:31]
    ds_read_b128 v[52:55], v120 offset:2752
    s_waitcnt lgkmcnt(10)
    v_mfma_f32_16x16x32_bf16 v[12:15], v[108:111], v[64:67], v[12:15]
    v_mfma_f32_16x16x32_bf16 v[16:19], v[108:111], v[68:71], v[16:19]
    ds_read2_b32 v[104:105], v118 offset0:102 offset1:100
    v_mfma_f32_16x16x32_bf16 v[20:23], v[108:111], v[72:75], v[20:23]
    ds_read2_b32 v[106:107], v118 offset0:98 offset1:96
    v_mfma_f32_16x16x32_bf16 v[24:27], v[108:111], v[76:79], v[24:27]
    ds_read_b128 v[56:59], v120 offset:3264
    v_mfma_f32_16x16x32_bf16 v[28:31], v[108:111], v[80:83], v[28:31]
    ds_read_b128 v[60:63], v120 offset:3776
    s_waitcnt lgkmcnt(10)
    v_mfma_f32_16x16x32_bf16 v[16:19], v[96:99], v[64:67], v[16:19]
    v_mfma_f32_16x16x32_bf16 v[20:23], v[96:99], v[68:71], v[20:23]
    ds_read2_b32 v[108:109], v119 offset0:102 offset1:100
    v_mfma_f32_16x16x32_bf16 v[24:27], v[96:99], v[72:75], v[24:27]
    v_mfma_f32_16x16x32_bf16 v[28:31], v[96:99], v[76:79], v[28:31]
    ds_read2_b32 v[110:111], v119 offset0:98 offset1:96
    s_waitcnt lgkmcnt(8)
    v_mfma_f32_16x16x32_bf16 v[20:23], v[100:103], v[64:67], v[20:23]
    v_mfma_f32_16x16x32_bf16 v[24:27], v[100:103], v[68:71], v[24:27]
    ds_read2_b32 v[96:97], v112 offset0:134 offset1:132
    v_mfma_f32_16x16x32_bf16 v[28:31], v[100:103], v[72:75], v[28:31]
    ds_read2_b32 v[98:99], v112 offset0:130 offset1:128
    s_waitcnt lgkmcnt(6)
    v_mfma_f32_16x16x32_bf16 v[24:27], v[104:107], v[64:67], v[24:27]
    ds_read2_b32 v[100:101], v113 offset0:134 offset1:132
    v_mfma_f32_16x16x32_bf16 v[28:31], v[104:107], v[68:71], v[28:31]
    ds_read2_b32 v[102:103], v113 offset0:130 offset1:128
    s_waitcnt lgkmcnt(4)
    v_mfma_f32_16x16x32_bf16 v[28:31], v[108:111], v[64:67], v[28:31]
    ds_read2_b32 v[104:105], v114 offset0:134 offset1:132
    ds_read2_b32 v[106:107], v114 offset0:130 offset1:128
    s_waitcnt lgkmcnt(4)
    s_waitcnt lgkmcnt(8)
    v_mfma_f32_16x16x32_bf16 v[0:3], v[96:99], v[32:35], v[0:3]
    v_mfma_f32_16x16x32_bf16 v[4:7], v[96:99], v[36:39], v[4:7]
    ds_read2_b32 v[108:109], v115 offset0:134 offset1:132
    v_mfma_f32_16x16x32_bf16 v[8:11], v[96:99], v[40:43], v[8:11]
    v_mfma_f32_16x16x32_bf16 v[12:15], v[96:99], v[44:47], v[12:15]
    ds_read2_b32 v[110:111], v115 offset0:130 offset1:128
    v_mfma_f32_16x16x32_bf16 v[16:19], v[96:99], v[48:51], v[16:19]
    v_mfma_f32_16x16x32_bf16 v[20:23], v[96:99], v[52:55], v[20:23]
    ds_read_b128 v[64:67], v120 offset:128
    v_mfma_f32_16x16x32_bf16 v[24:27], v[96:99], v[56:59], v[24:27]
    v_mfma_f32_16x16x32_bf16 v[28:31], v[96:99], v[60:63], v[28:31]
    ds_read_b128 v[68:71], v120 offset:640
    s_waitcnt lgkmcnt(6)
    v_mfma_f32_16x16x32_bf16 v[4:7], v[100:103], v[32:35], v[4:7]
    v_mfma_f32_16x16x32_bf16 v[8:11], v[100:103], v[36:39], v[8:11]
    ds_read2_b32 v[96:97], v116 offset0:134 offset1:132
    v_mfma_f32_16x16x32_bf16 v[12:15], v[100:103], v[40:43], v[12:15]
    v_mfma_f32_16x16x32_bf16 v[16:19], v[100:103], v[44:47], v[16:19]
    ds_read2_b32 v[98:99], v116 offset0:130 offset1:128
    v_mfma_f32_16x16x32_bf16 v[20:23], v[100:103], v[48:51], v[20:23]
    v_mfma_f32_16x16x32_bf16 v[24:27], v[100:103], v[52:55], v[24:27]
    ds_read_b128 v[72:75], v120 offset:1152
    v_mfma_f32_16x16x32_bf16 v[28:31], v[100:103], v[56:59], v[28:31]
    ds_read_b128 v[76:79], v120 offset:1664
    s_waitcnt lgkmcnt(8)
    v_mfma_f32_16x16x32_bf16 v[8:11], v[104:107], v[32:35], v[8:11]
    v_mfma_f32_16x16x32_bf16 v[12:15], v[104:107], v[36:39], v[12:15]
    ds_read2_b32 v[100:101], v117 offset0:134 offset1:132
    v_mfma_f32_16x16x32_bf16 v[16:19], v[104:107], v[40:43], v[16:19]
    ds_read2_b32 v[102:103], v117 offset0:130 offset1:128
    v_mfma_f32_16x16x32_bf16 v[20:23], v[104:107], v[44:47], v[20:23]
    v_mfma_f32_16x16x32_bf16 v[24:27], v[104:107], v[48:51], v[24:27]
    ds_read_b128 v[80:83], v120 offset:2176
    v_mfma_f32_16x16x32_bf16 v[28:31], v[104:107], v[52:55], v[28:31]
    ds_read_b128 v[84:87], v120 offset:2688
    s_waitcnt lgkmcnt(10)
    v_mfma_f32_16x16x32_bf16 v[12:15], v[108:111], v[32:35], v[12:15]
    v_mfma_f32_16x16x32_bf16 v[16:19], v[108:111], v[36:39], v[16:19]
    ds_read2_b32 v[104:105], v118 offset0:134 offset1:132
    v_mfma_f32_16x16x32_bf16 v[20:23], v[108:111], v[40:43], v[20:23]
    ds_read2_b32 v[106:107], v118 offset0:130 offset1:128
    v_mfma_f32_16x16x32_bf16 v[24:27], v[108:111], v[44:47], v[24:27]
    ds_read_b128 v[88:91], v120 offset:3200
    v_mfma_f32_16x16x32_bf16 v[28:31], v[108:111], v[48:51], v[28:31]
    ds_read_b128 v[92:95], v120 offset:3712
    s_waitcnt lgkmcnt(10)
    v_mfma_f32_16x16x32_bf16 v[16:19], v[96:99], v[32:35], v[16:19]
    v_mfma_f32_16x16x32_bf16 v[20:23], v[96:99], v[36:39], v[20:23]
    ds_read2_b32 v[108:109], v119 offset0:134 offset1:132
    v_mfma_f32_16x16x32_bf16 v[24:27], v[96:99], v[40:43], v[24:27]
    v_mfma_f32_16x16x32_bf16 v[28:31], v[96:99], v[44:47], v[28:31]
    ds_read2_b32 v[110:111], v119 offset0:130 offset1:128
    s_waitcnt lgkmcnt(8)
    v_mfma_f32_16x16x32_bf16 v[20:23], v[100:103], v[32:35], v[20:23]
    v_mfma_f32_16x16x32_bf16 v[24:27], v[100:103], v[36:39], v[24:27]
    ds_read2_b32 v[96:97], v112 offset0:166 offset1:164
    v_mfma_f32_16x16x32_bf16 v[28:31], v[100:103], v[40:43], v[28:31]
    ds_read2_b32 v[98:99], v112 offset0:162 offset1:160
    s_waitcnt lgkmcnt(6)
    v_mfma_f32_16x16x32_bf16 v[24:27], v[104:107], v[32:35], v[24:27]
    ds_read2_b32 v[100:101], v113 offset0:166 offset1:164
    v_mfma_f32_16x16x32_bf16 v[28:31], v[104:107], v[36:39], v[28:31]
    ds_read2_b32 v[102:103], v113 offset0:162 offset1:160
    s_waitcnt lgkmcnt(4)
    v_mfma_f32_16x16x32_bf16 v[28:31], v[108:111], v[32:35], v[28:31]
    ds_read2_b32 v[104:105], v114 offset0:166 offset1:164
    ds_read2_b32 v[106:107], v114 offset0:162 offset1:160
    s_waitcnt lgkmcnt(4)
    s_waitcnt lgkmcnt(8)
    v_mfma_f32_16x16x32_bf16 v[0:3], v[96:99], v[64:67], v[0:3]
    v_mfma_f32_16x16x32_bf16 v[4:7], v[96:99], v[68:71], v[4:7]
    ds_read2_b32 v[108:109], v115 offset0:166 offset1:164
    v_mfma_f32_16x16x32_bf16 v[8:11], v[96:99], v[72:75], v[8:11]
    v_mfma_f32_16x16x32_bf16 v[12:15], v[96:99], v[76:79], v[12:15]
    ds_read2_b32 v[110:111], v115 offset0:162 offset1:160
    v_mfma_f32_16x16x32_bf16 v[16:19], v[96:99], v[80:83], v[16:19]
    v_mfma_f32_16x16x32_bf16 v[20:23], v[96:99], v[84:87], v[20:23]
    ds_read_b128 v[32:35], v120 offset:64
    v_mfma_f32_16x16x32_bf16 v[24:27], v[96:99], v[88:91], v[24:27]
    v_mfma_f32_16x16x32_bf16 v[28:31], v[96:99], v[92:95], v[28:31]
    ds_read_b128 v[36:39], v120 offset:576
    s_waitcnt lgkmcnt(6)
    v_mfma_f32_16x16x32_bf16 v[4:7], v[100:103], v[64:67], v[4:7]
    v_mfma_f32_16x16x32_bf16 v[8:11], v[100:103], v[68:71], v[8:11]
    ds_read2_b32 v[96:97], v116 offset0:166 offset1:164
    v_mfma_f32_16x16x32_bf16 v[12:15], v[100:103], v[72:75], v[12:15]
    v_mfma_f32_16x16x32_bf16 v[16:19], v[100:103], v[76:79], v[16:19]
    ds_read2_b32 v[98:99], v116 offset0:162 offset1:160
    v_mfma_f32_16x16x32_bf16 v[20:23], v[100:103], v[80:83], v[20:23]
    v_mfma_f32_16x16x32_bf16 v[24:27], v[100:103], v[84:87], v[24:27]
    ds_read_b128 v[40:43], v120 offset:1088
    v_mfma_f32_16x16x32_bf16 v[28:31], v[100:103], v[88:91], v[28:31]
    ds_read_b128 v[44:47], v120 offset:1600
    s_waitcnt lgkmcnt(8)
    v_mfma_f32_16x16x32_bf16 v[8:11], v[104:107], v[64:67], v[8:11]
    v_mfma_f32_16x16x32_bf16 v[12:15], v[104:107], v[68:71], v[12:15]
    ds_read2_b32 v[100:101], v117 offset0:166 offset1:164
    v_mfma_f32_16x16x32_bf16 v[16:19], v[104:107], v[72:75], v[16:19]
    ds_read2_b32 v[102:103], v117 offset0:162 offset1:160
    v_mfma_f32_16x16x32_bf16 v[20:23], v[104:107], v[76:79], v[20:23]
    v_mfma_f32_16x16x32_bf16 v[24:27], v[104:107], v[80:83], v[24:27]
    ds_read_b128 v[48:51], v120 offset:2112
    v_mfma_f32_16x16x32_bf16 v[28:31], v[104:107], v[84:87], v[28:31]
    ds_read_b128 v[52:55], v120 offset:2624
    s_waitcnt lgkmcnt(10)
    v_mfma_f32_16x16x32_bf16 v[12:15], v[108:111], v[64:67], v[12:15]
    v_mfma_f32_16x16x32_bf16 v[16:19], v[108:111], v[68:71], v[16:19]
    ds_read2_b32 v[104:105], v118 offset0:166 offset1:164
    v_mfma_f32_16x16x32_bf16 v[20:23], v[108:111], v[72:75], v[20:23]
    ds_read2_b32 v[106:107], v118 offset0:162 offset1:160
    v_mfma_f32_16x16x32_bf16 v[24:27], v[108:111], v[76:79], v[24:27]
    ds_read_b128 v[56:59], v120 offset:3136
    v_mfma_f32_16x16x32_bf16 v[28:31], v[108:111], v[80:83], v[28:31]
    ds_read_b128 v[60:63], v120 offset:3648
    s_waitcnt lgkmcnt(10)
    v_mfma_f32_16x16x32_bf16 v[16:19], v[96:99], v[64:67], v[16:19]
    v_mfma_f32_16x16x32_bf16 v[20:23], v[96:99], v[68:71], v[20:23]
    ds_read2_b32 v[108:109], v119 offset0:166 offset1:164
    v_mfma_f32_16x16x32_bf16 v[24:27], v[96:99], v[72:75], v[24:27]
    v_mfma_f32_16x16x32_bf16 v[28:31], v[96:99], v[76:79], v[28:31]
    ds_read2_b32 v[110:111], v119 offset0:162 offset1:160
    s_waitcnt lgkmcnt(8)
    v_mfma_f32_16x16x32_bf16 v[20:23], v[100:103], v[64:67], v[20:23]
    v_mfma_f32_16x16x32_bf16 v[24:27], v[100:103], v[68:71], v[24:27]
    ds_read2_b32 v[96:97], v112 offset0:198 offset1:196
    v_mfma_f32_16x16x32_bf16 v[28:31], v[100:103], v[72:75], v[28:31]
    ds_read2_b32 v[98:99], v112 offset0:194 offset1:192
    s_waitcnt lgkmcnt(6)
    v_mfma_f32_16x16x32_bf16 v[24:27], v[104:107], v[64:67], v[24:27]
    ds_read2_b32 v[100:101], v113 offset0:198 offset1:196
    v_mfma_f32_16x16x32_bf16 v[28:31], v[104:107], v[68:71], v[28:31]
    ds_read2_b32 v[102:103], v113 offset0:194 offset1:192
    s_waitcnt lgkmcnt(4)
    v_mfma_f32_16x16x32_bf16 v[28:31], v[108:111], v[64:67], v[28:31]
    ds_read2_b32 v[104:105], v114 offset0:198 offset1:196
    ds_read2_b32 v[106:107], v114 offset0:194 offset1:192
    s_waitcnt lgkmcnt(4)
    s_waitcnt lgkmcnt(8)
    v_mfma_f32_16x16x32_bf16 v[0:3], v[96:99], v[32:35], v[0:3]
    v_mfma_f32_16x16x32_bf16 v[4:7], v[96:99], v[36:39], v[4:7]
    ds_read2_b32 v[108:109], v115 offset0:198 offset1:196
    v_mfma_f32_16x16x32_bf16 v[8:11], v[96:99], v[40:43], v[8:11]
    v_mfma_f32_16x16x32_bf16 v[12:15], v[96:99], v[44:47], v[12:15]
    ds_read2_b32 v[110:111], v115 offset0:194 offset1:192
    v_mfma_f32_16x16x32_bf16 v[16:19], v[96:99], v[48:51], v[16:19]
    v_mfma_f32_16x16x32_bf16 v[20:23], v[96:99], v[52:55], v[20:23]
    ds_read_b128 v[64:67], v120 offset:0
    v_mfma_f32_16x16x32_bf16 v[24:27], v[96:99], v[56:59], v[24:27]
    v_mfma_f32_16x16x32_bf16 v[28:31], v[96:99], v[60:63], v[28:31]
    ds_read_b128 v[68:71], v120 offset:512
    s_waitcnt lgkmcnt(6)
    v_mfma_f32_16x16x32_bf16 v[4:7], v[100:103], v[32:35], v[4:7]
    v_mfma_f32_16x16x32_bf16 v[8:11], v[100:103], v[36:39], v[8:11]
    ds_read2_b32 v[96:97], v116 offset0:198 offset1:196
    v_mfma_f32_16x16x32_bf16 v[12:15], v[100:103], v[40:43], v[12:15]
    v_mfma_f32_16x16x32_bf16 v[16:19], v[100:103], v[44:47], v[16:19]
    ds_read2_b32 v[98:99], v116 offset0:194 offset1:192
    v_mfma_f32_16x16x32_bf16 v[20:23], v[100:103], v[48:51], v[20:23]
    v_mfma_f32_16x16x32_bf16 v[24:27], v[100:103], v[52:55], v[24:27]
    ds_read_b128 v[72:75], v120 offset:1024
    v_mfma_f32_16x16x32_bf16 v[28:31], v[100:103], v[56:59], v[28:31]
    ds_read_b128 v[76:79], v120 offset:1536
    s_waitcnt lgkmcnt(8)
    v_mfma_f32_16x16x32_bf16 v[8:11], v[104:107], v[32:35], v[8:11]
    v_mfma_f32_16x16x32_bf16 v[12:15], v[104:107], v[36:39], v[12:15]
    ds_read2_b32 v[100:101], v117 offset0:198 offset1:196
    v_mfma_f32_16x16x32_bf16 v[16:19], v[104:107], v[40:43], v[16:19]
    ds_read2_b32 v[102:103], v117 offset0:194 offset1:192
    v_mfma_f32_16x16x32_bf16 v[20:23], v[104:107], v[44:47], v[20:23]
    v_mfma_f32_16x16x32_bf16 v[24:27], v[104:107], v[48:51], v[24:27]
    ds_read_b128 v[80:83], v120 offset:2048
    v_mfma_f32_16x16x32_bf16 v[28:31], v[104:107], v[52:55], v[28:31]
    ds_read_b128 v[84:87], v120 offset:2560
    s_waitcnt lgkmcnt(10)
    v_mfma_f32_16x16x32_bf16 v[12:15], v[108:111], v[32:35], v[12:15]
    v_mfma_f32_16x16x32_bf16 v[16:19], v[108:111], v[36:39], v[16:19]
    ds_read2_b32 v[104:105], v118 offset0:198 offset1:196
    v_mfma_f32_16x16x32_bf16 v[20:23], v[108:111], v[40:43], v[20:23]
    ds_read2_b32 v[106:107], v118 offset0:194 offset1:192
    v_mfma_f32_16x16x32_bf16 v[24:27], v[108:111], v[44:47], v[24:27]
    ds_read_b128 v[88:91], v120 offset:3072
    v_mfma_f32_16x16x32_bf16 v[28:31], v[108:111], v[48:51], v[28:31]
    ds_read_b128 v[92:95], v120 offset:3584
    s_waitcnt lgkmcnt(10)
    v_mfma_f32_16x16x32_bf16 v[16:19], v[96:99], v[32:35], v[16:19]
    v_mfma_f32_16x16x32_bf16 v[20:23], v[96:99], v[36:39], v[20:23]
    ds_read2_b32 v[108:109], v119 offset0:198 offset1:196
    v_mfma_f32_16x16x32_bf16 v[24:27], v[96:99], v[40:43], v[24:27]
    v_mfma_f32_16x16x32_bf16 v[28:31], v[96:99], v[44:47], v[28:31]
    ds_read2_b32 v[110:111], v119 offset0:194 offset1:192
    s_waitcnt lgkmcnt(8)
    v_mfma_f32_16x16x32_bf16 v[20:23], v[100:103], v[32:35], v[20:23]
    v_mfma_f32_16x16x32_bf16 v[24:27], v[100:103], v[36:39], v[24:27]
    ds_read2_b32 v[96:97], v112 offset0:230 offset1:228
    v_mfma_f32_16x16x32_bf16 v[28:31], v[100:103], v[40:43], v[28:31]
    ds_read2_b32 v[98:99], v112 offset0:226 offset1:224
    s_waitcnt lgkmcnt(6)
    v_mfma_f32_16x16x32_bf16 v[24:27], v[104:107], v[32:35], v[24:27]
    ds_read2_b32 v[100:101], v113 offset0:230 offset1:228
    v_mfma_f32_16x16x32_bf16 v[28:31], v[104:107], v[36:39], v[28:31]
    ds_read2_b32 v[102:103], v113 offset0:226 offset1:224
    s_waitcnt lgkmcnt(4)
    v_mfma_f32_16x16x32_bf16 v[28:31], v[108:111], v[32:35], v[28:31]
    ds_read2_b32 v[104:105], v114 offset0:230 offset1:228
    ds_read2_b32 v[106:107], v114 offset0:226 offset1:224
    s_waitcnt lgkmcnt(4)
    s_waitcnt lgkmcnt(8)
    v_mfma_f32_16x16x32_bf16 v[0:3], v[96:99], v[64:67], v[0:3]
    v_mfma_f32_16x16x32_bf16 v[4:7], v[96:99], v[68:71], v[4:7]
    v_mfma_f32_16x16x32_bf16 v[8:11], v[96:99], v[72:75], v[8:11]
    v_mfma_f32_16x16x32_bf16 v[12:15], v[96:99], v[76:79], v[12:15]
    ds_read2_b32 v[108:109], v115 offset0:230 offset1:228
    v_mfma_f32_16x16x32_bf16 v[16:19], v[96:99], v[80:83], v[16:19]
    v_mfma_f32_16x16x32_bf16 v[20:23], v[96:99], v[84:87], v[20:23]
    v_mfma_f32_16x16x32_bf16 v[24:27], v[96:99], v[88:91], v[24:27]
    v_mfma_f32_16x16x32_bf16 v[28:31], v[96:99], v[92:95], v[28:31]
    ds_read2_b32 v[110:111], v115 offset0:226 offset1:224
    s_waitcnt lgkmcnt(4)
    v_mfma_f32_16x16x32_bf16 v[4:7], v[100:103], v[64:67], v[4:7]
    v_mfma_f32_16x16x32_bf16 v[8:11], v[100:103], v[68:71], v[8:11]
    v_mfma_f32_16x16x32_bf16 v[12:15], v[100:103], v[72:75], v[12:15]
    v_mfma_f32_16x16x32_bf16 v[16:19], v[100:103], v[76:79], v[16:19]
    ds_read2_b32 v[96:97], v116 offset0:230 offset1:228
    v_mfma_f32_16x16x32_bf16 v[20:23], v[100:103], v[80:83], v[20:23]
    v_mfma_f32_16x16x32_bf16 v[24:27], v[100:103], v[84:87], v[24:27]
    v_mfma_f32_16x16x32_bf16 v[28:31], v[100:103], v[88:91], v[28:31]
    ds_read2_b32 v[98:99], v116 offset0:226 offset1:224
    s_waitcnt lgkmcnt(4)
    v_mfma_f32_16x16x32_bf16 v[8:11], v[104:107], v[64:67], v[8:11]
    v_mfma_f32_16x16x32_bf16 v[12:15], v[104:107], v[68:71], v[12:15]
    v_mfma_f32_16x16x32_bf16 v[16:19], v[104:107], v[72:75], v[16:19]
    ds_read2_b32 v[100:101], v117 offset0:230 offset1:228
    v_mfma_f32_16x16x32_bf16 v[20:23], v[104:107], v[76:79], v[20:23]
    v_mfma_f32_16x16x32_bf16 v[24:27], v[104:107], v[80:83], v[24:27]
    v_mfma_f32_16x16x32_bf16 v[28:31], v[104:107], v[84:87], v[28:31]
    ds_read2_b32 v[102:103], v117 offset0:226 offset1:224
    s_waitcnt lgkmcnt(4)
    v_mfma_f32_16x16x32_bf16 v[12:15], v[108:111], v[64:67], v[12:15]
    v_mfma_f32_16x16x32_bf16 v[16:19], v[108:111], v[68:71], v[16:19]
    v_mfma_f32_16x16x32_bf16 v[20:23], v[108:111], v[72:75], v[20:23]
    ds_read2_b32 v[104:105], v118 offset0:230 offset1:228
    v_mfma_f32_16x16x32_bf16 v[24:27], v[108:111], v[76:79], v[24:27]
    v_mfma_f32_16x16x32_bf16 v[28:31], v[108:111], v[80:83], v[28:31]
    ds_read2_b32 v[106:107], v118 offset0:226 offset1:224
    s_waitcnt lgkmcnt(4)
    v_mfma_f32_16x16x32_bf16 v[16:19], v[96:99], v[64:67], v[16:19]
    v_mfma_f32_16x16x32_bf16 v[20:23], v[96:99], v[68:71], v[20:23]
    ds_read2_b32 v[108:109], v119 offset0:230 offset1:228
    v_mfma_f32_16x16x32_bf16 v[24:27], v[96:99], v[72:75], v[24:27]
    v_mfma_f32_16x16x32_bf16 v[28:31], v[96:99], v[76:79], v[28:31]
    ds_read2_b32 v[110:111], v119 offset0:226 offset1:224
    s_waitcnt lgkmcnt(4)
    v_mfma_f32_16x16x32_bf16 v[20:23], v[100:103], v[64:67], v[20:23]
    v_mfma_f32_16x16x32_bf16 v[24:27], v[100:103], v[68:71], v[24:27]
    v_mfma_f32_16x16x32_bf16 v[28:31], v[100:103], v[72:75], v[28:31]
    s_waitcnt lgkmcnt(2)
    v_mfma_f32_16x16x32_bf16 v[24:27], v[104:107], v[64:67], v[24:27]
    v_mfma_f32_16x16x32_bf16 v[28:31], v[104:107], v[68:71], v[28:31]
    s_waitcnt lgkmcnt(0)
    v_mfma_f32_16x16x32_bf16 v[28:31], v[108:111], v[64:67], v[28:31]
    s_nop 7
    v_and_b32 v122, 15, v121
    v_lshrrev_b32 v123, 4, v121
    v_lshlrev_b32 v124, 5, v122
    v_lshl_add_u32 v124, v123, 3, v124
    s_add_u32 s28, s30, 8768
    v_add_u32 v125, s28, v124
    s_lshl_b32 s28, s88, 12
    s_add_u32 s28, s28, 8912896
    ds_read_b64 v[32:33], v125 offset:0
    ds_read_b64 v[34:35], v125 offset:512
    ds_read_b64 v[36:37], v125 offset:1024
    ds_read_b64 v[38:39], v125 offset:1536
    ds_read_b64 v[40:41], v125 offset:2048
    ds_read_b64 v[42:43], v125 offset:2560
    ds_read_b64 v[44:45], v125 offset:3072
    ds_read_b64 v[46:47], v125 offset:3584
    s_waitcnt lgkmcnt(0)
    v_and_b32 v126, 15, v121
    v_lshlrev_b32 v126, 5, v126
    v_bfe_u32 v127, v121, 5, 1
    v_lshl_add_u32 v126, v127, 4, v126
    v_bfe_u32 v127, v121, 4, 1
    v_lshl_add_u32 v126, v127, 9, v126
    v_lshlrev_b32 v48, 16, v32
    v_and_b32 v49, 0xffff0000, v32
    v_lshlrev_b32 v50, 16, v33
    v_and_b32 v51, 0xffff0000, v33
    v_fmac_f32 v0, s33, v48
    v_fmac_f32 v1, s33, v49
    v_fmac_f32 v2, s33, v50
    v_fmac_f32 v3, s33, v51
    v_lshlrev_b32 v52, 16, v34
    v_and_b32 v53, 0xffff0000, v34
    v_lshlrev_b32 v54, 16, v35
    v_and_b32 v55, 0xffff0000, v35
    v_fmac_f32 v4, s33, v52
    v_fmac_f32 v5, s33, v53
    v_fmac_f32 v6, s33, v54
    v_fmac_f32 v7, s33, v55
    v_cvt_pk_bf16_f32 v56, v0, v1
    v_cvt_pk_bf16_f32 v57, v2, v3
    v_cvt_pk_bf16_f32 v58, v4, v5
    v_cvt_pk_bf16_f32 v59, v6, v7
    s_nop 1
    v_permlane16_swap_b32 v56, v58
    v_permlane16_swap_b32 v57, v59
    s_nop 0
    buffer_store_dwordx4 v[56:59], v126, s[36:39], s28 offen offset:0 sc1
    v_lshlrev_b32 v48, 16, v36
    v_and_b32 v49, 0xffff0000, v36
    v_lshlrev_b32 v50, 16, v37
    v_and_b32 v51, 0xffff0000, v37
    v_fmac_f32 v8, s33, v48
    v_fmac_f32 v9, s33, v49
    v_fmac_f32 v10, s33, v50
    v_fmac_f32 v11, s33, v51
    v_lshlrev_b32 v52, 16, v38
    v_and_b32 v53, 0xffff0000, v38
    v_lshlrev_b32 v54, 16, v39
    v_and_b32 v55, 0xffff0000, v39
    v_fmac_f32 v12, s33, v52
    v_fmac_f32 v13, s33, v53
    v_fmac_f32 v14, s33, v54
    v_fmac_f32 v15, s33, v55
    v_cvt_pk_bf16_f32 v60, v8, v9
    v_cvt_pk_bf16_f32 v61, v10, v11
    v_cvt_pk_bf16_f32 v62, v12, v13
    v_cvt_pk_bf16_f32 v63, v14, v15
    s_nop 1
    v_permlane16_swap_b32 v60, v62
    v_permlane16_swap_b32 v61, v63
    s_nop 0
    buffer_store_dwordx4 v[60:63], v126, s[36:39], s28 offen offset:1024 sc1
    v_lshlrev_b32 v48, 16, v40
    v_and_b32 v49, 0xffff0000, v40
    v_lshlrev_b32 v50, 16, v41
    v_and_b32 v51, 0xffff0000, v41
    v_fmac_f32 v16, s33, v48
    v_fmac_f32 v17, s33, v49
    v_fmac_f32 v18, s33, v50
    v_fmac_f32 v19, s33, v51
    v_lshlrev_b32 v52, 16, v42
    v_and_b32 v53, 0xffff0000, v42
    v_lshlrev_b32 v54, 16, v43
    v_and_b32 v55, 0xffff0000, v43
    v_fmac_f32 v20, s33, v52
    v_fmac_f32 v21, s33, v53
    v_fmac_f32 v22, s33, v54
    v_fmac_f32 v23, s33, v55
    v_cvt_pk_bf16_f32 v56, v16, v17
    v_cvt_pk_bf16_f32 v57, v18, v19
    v_cvt_pk_bf16_f32 v58, v20, v21
    v_cvt_pk_bf16_f32 v59, v22, v23
    s_nop 1
    v_permlane16_swap_b32 v56, v58
    v_permlane16_swap_b32 v57, v59
    s_nop 0
    buffer_store_dwordx4 v[56:59], v126, s[36:39], s28 offen offset:2048 sc1
    v_lshlrev_b32 v48, 16, v44
    v_and_b32 v49, 0xffff0000, v44
    v_lshlrev_b32 v50, 16, v45
    v_and_b32 v51, 0xffff0000, v45
    v_fmac_f32 v24, s33, v48
    v_fmac_f32 v25, s33, v49
    v_fmac_f32 v26, s33, v50
    v_fmac_f32 v27, s33, v51
    v_lshlrev_b32 v52, 16, v46
    v_and_b32 v53, 0xffff0000, v46
    v_lshlrev_b32 v54, 16, v47
    v_and_b32 v55, 0xffff0000, v47
    v_fmac_f32 v28, s33, v52
    v_fmac_f32 v29, s33, v53
    v_fmac_f32 v30, s33, v54
    v_fmac_f32 v31, s33, v55
    v_cvt_pk_bf16_f32 v60, v24, v25
    v_cvt_pk_bf16_f32 v61, v26, v27
    v_cvt_pk_bf16_f32 v62, v28, v29
    v_cvt_pk_bf16_f32 v63, v30, v31
    s_nop 1
    v_permlane16_swap_b32 v60, v62
    v_permlane16_swap_b32 v61, v63
    s_nop 0
    buffer_store_dwordx4 v[60:63], v126, s[36:39], s28 offen offset:3072 sc1
    s_waitcnt vmcnt(0)
    s_lshl_b32 s28, s20, 5
    s_add_u32 s28, s28, s21
    s_lshl_b32 s28, s28, 7
    s_lshl_b32 s29, s24, 2
    s_add_u32 s28, s28, s29
    s_add_u32 s28, s28, 13721600
    v_mov_b32 v122, 0
    v_mov_b32 v123, 1
    s_mov_b64 s[92:93], exec
    s_mov_b64 exec, 1
    buffer_store_dword v123, v122, s[36:39], s28 offen sc1
    s_mov_b64 exec, s[92:93]
    s_branch Lmain_end
Lrole_w:
    s_mov_b32 s40, s80
    s_and_b32 s41, s81, 0xffff
    s_mov_b32 s42, 1966080
    s_mov_b32 s43, 0x20000
    s_sub_u32 s99, s21, 16
    s_lshl_b32 s99, s99, 3
    s_add_u32 s99, s99, s20
    s_mov_b32 s100, 89478486
    s_mov_b32 s98, 137472
    s_mov_b32 s94, 429496730
    v_add_u32 v40, 0, v11
    v_mul_hi_u32 v41, v40, s94
    v_mul_u32_u24 v42, 10, v41
    v_sub_u32 v42, v40, v42
    v_mul_u32_u24 v41, 1280, v41
    v_lshl_add_u32 v32, v42, 4, v41
    v_add_u32 v40, 64, v11
    v_mul_hi_u32 v41, v40, s94
    v_mul_u32_u24 v42, 10, v41
    v_sub_u32 v42, v40, v42
    v_mul_u32_u24 v41, 1280, v41
    v_lshl_add_u32 v33, v42, 4, v41
    v_add_u32 v40, 128, v11
    v_mul_hi_u32 v41, v40, s94
    v_mul_u32_u24 v42, 10, v41
    v_sub_u32 v42, v40, v42
    v_mul_u32_u24 v41, 1280, v41
    v_lshl_add_u32 v34, v42, 4, v41
    v_add_u32 v40, 192, v11
    v_mul_hi_u32 v41, v40, s94
    v_mul_u32_u24 v42, 10, v41
    v_sub_u32 v42, v40, v42
    v_mul_u32_u24 v41, 1280, v41
    v_lshl_add_u32 v35, v42, 4, v41
    v_add_u32 v40, 256, v11
    v_mul_hi_u32 v41, v40, s94
    v_mul_u32_u24 v42, 10, v41
    v_sub_u32 v42, v40, v42
    v_mul_u32_u24 v41, 1280, v41
    v_lshl_add_u32 v36, v42, 4, v41
    v_bfe_u32 v40, v11, 5, 1
    v_lshlrev_b32 v40, 4, v40
    v_bfe_u32 v41, v11, 4, 1
    v_lshl_add_u32 v40, v41, 2, v40
    v_bfe_u32 v41, v11, 2, 2
    v_add_u32 v40, v40, v41
    v_mul_u32_u24 v40, 160, v40
    v_and_b32 v41, 3, v11
    v_mul_u32_u24 v41, 40, v41
    v_add_u32 v40, v40, v41
    v_add_u32 v38, s98, v40
    v_lshlrev_b32 v39, 4, v11
    s_barrier
    s_mul_i32 s94, s99, 3
    s_add_u32 s94, s94, 0
    s_mul_hi_u32 s95, s94, s100
    s_mul_i32 s96, s95, 48
    s_sub_u32 s94, s94, s96
    s_mul_i32 s96, s94, 40960
    s_mul_i32 s97, s95, 160
    s_add_u32 s96, s96, s97
    s_mul_i32 s95, s95, 240
    s_add_u32 s95, s95, s94
    s_lshl_b32 s95, s95, 10
    s_add_u32 s88, s95, 11534336
    buffer_load_dwordx4 v[64:67], v32, s[40:43], s96 offen
    buffer_load_dwordx4 v[68:71], v33, s[40:43], s96 offen
    buffer_load_dwordx4 v[72:75], v34, s[40:43], s96 offen
    buffer_load_dwordx4 v[76:79], v35, s[40:43], s96 offen
    buffer_load_dwordx4 v[80:83], v36, s[40:43], s96 offen
    s_mul_i32 s94, s99, 3
    s_add_u32 s94, s94, 1
    s_mul_hi_u32 s95, s94, s100
    s_mul_i32 s96, s95, 48
    s_sub_u32 s94, s94, s96
    s_mul_i32 s96, s94, 40960
    s_mul_i32 s97, s95, 160
    s_add_u32 s96, s96, s97
    s_mul_i32 s95, s95, 240
    s_add_u32 s95, s95, s94
    s_lshl_b32 s95, s95, 10
    s_add_u32 s89, s95, 11534336
    buffer_load_dwordx4 v[84:87], v32, s[40:43], s96 offen
    buffer_load_dwordx4 v[88:91], v33, s[40:43], s96 offen
    buffer_load_dwordx4 v[92:95], v34, s[40:43], s96 offen
    buffer_load_dwordx4 v[96:99], v35, s[40:43], s96 offen
    buffer_load_dwordx4 v[100:103], v36, s[40:43], s96 offen
    s_mul_i32 s94, s99, 3
    s_add_u32 s94, s94, 2
    s_mul_hi_u32 s95, s94, s100
    s_mul_i32 s96, s95, 48
    s_sub_u32 s94, s94, s96
    s_mul_i32 s96, s94, 40960
    s_mul_i32 s97, s95, 160
    s_add_u32 s96, s96, s97
    s_mul_i32 s95, s95, 240
    s_add_u32 s95, s95, s94
    s_lshl_b32 s95, s95, 10
    s_add_u32 s90, s95, 11534336
    buffer_load_dwordx4 v[104:107], v32, s[40:43], s96 offen
    s_barrier
    buffer_load_dwordx4 v[108:111], v33, s[40:43], s96 offen
    buffer_load_dwordx4 v[112:115], v34, s[40:43], s96 offen
    buffer_load_dwordx4 v[116:119], v35, s[40:43], s96 offen
    buffer_load_dwordx4 v[120:123], v36, s[40:43], s96 offen
    s_waitcnt vmcnt(10)
    v_lshlrev_b32 v37, 4, v11
    v_add_u32 v37, s98, v37
    ds_write_b128 v37, v[64:67] offset:0
    ds_write_b128 v37, v[68:71] offset:1024
    ds_write_b128 v37, v[72:75] offset:2048
    ds_write_b128 v37, v[76:79] offset:3072
    ds_write_b128 v37, v[80:83] offset:4096
    ds_read_b64_tr_b16 v[40:41], v38 offset:0
    ds_read_b64_tr_b16 v[42:43], v38 offset:1280
    ds_read_b64_tr_b16 v[44:45], v38 offset:8
    ds_read_b64_tr_b16 v[46:47], v38 offset:1288
    ds_read_b64_tr_b16 v[48:49], v38 offset:16
    ds_read_b64_tr_b16 v[50:51], v38 offset:1296
    ds_read_b64_tr_b16 v[52:53], v38 offset:24
    ds_read_b64_tr_b16 v[54:55], v38 offset:1304
    ds_read_b64_tr_b16 v[56:57], v38 offset:32
    ds_read_b64_tr_b16 v[58:59], v38 offset:1312
    s_waitcnt lgkmcnt(8)
    s_add_u32 s95, s88, 0
    buffer_store_dwordx4 v[40:43], v39, s[36:39], s95 offen sc1
    s_waitcnt lgkmcnt(6)
    s_add_u32 s95, s88, 49152
    buffer_store_dwordx4 v[44:47], v39, s[36:39], s95 offen sc1
    s_barrier
    s_waitcnt lgkmcnt(4)
    s_add_u32 s95, s88, 98304
    buffer_store_dwordx4 v[48:51], v39, s[36:39], s95 offen sc1
    s_waitcnt lgkmcnt(2)
    s_add_u32 s95, s88, 147456
    buffer_store_dwordx4 v[52:55], v39, s[36:39], s95 offen sc1
    s_waitcnt lgkmcnt(0)
    s_add_u32 s95, s88, 196608
    buffer_store_dwordx4 v[56:59], v39, s[36:39], s95 offen sc1
    s_waitcnt vmcnt(10)
    v_lshlrev_b32 v37, 4, v11
    v_add_u32 v37, s98, v37
    ds_write_b128 v37, v[84:87] offset:0
    ds_write_b128 v37, v[88:91] offset:1024
    ds_write_b128 v37, v[92:95] offset:2048
    ds_write_b128 v37, v[96:99] offset:3072
    ds_write_b128 v37, v[100:103] offset:4096
    ds_read_b64_tr_b16 v[40:41], v38 offset:0
    ds_read_b64_tr_b16 v[42:43], v38 offset:1280
    ds_read_b64_tr_b16 v[44:45], v38 offset:8
    ds_read_b64_tr_b16 v[46:47], v38 offset:1288
    ds_read_b64_tr_b16 v[48:49], v38 offset:16
    ds_read_b64_tr_b16 v[50:51], v38 offset:1296
    ds_read_b64_tr_b16 v[52:53], v38 offset:24
    ds_read_b64_tr_b16 v[54:55], v38 offset:1304
    ds_read_b64_tr_b16 v[56:57], v38 offset:32
    ds_read_b64_tr_b16 v[58:59], v38 offset:1312
    s_waitcnt lgkmcnt(8)
    s_barrier
    s_add_u32 s95, s89, 0
    buffer_store_dwordx4 v[40:43], v39, s[36:39], s95 offen sc1
    s_waitcnt lgkmcnt(6)
    s_add_u32 s95, s89, 49152
    buffer_store_dwordx4 v[44:47], v39, s[36:39], s95 offen sc1
    s_waitcnt lgkmcnt(4)
    s_add_u32 s95, s89, 98304
    buffer_store_dwordx4 v[48:51], v39, s[36:39], s95 offen sc1
    s_waitcnt lgkmcnt(2)
    s_add_u32 s95, s89, 147456
    buffer_store_dwordx4 v[52:55], v39, s[36:39], s95 offen sc1
    s_waitcnt lgkmcnt(0)
    s_add_u32 s95, s89, 196608
    buffer_store_dwordx4 v[56:59], v39, s[36:39], s95 offen sc1
    s_waitcnt vmcnt(10)
    v_lshlrev_b32 v37, 4, v11
    v_add_u32 v37, s98, v37
    ds_write_b128 v37, v[104:107] offset:0
    ds_write_b128 v37, v[108:111] offset:1024
    ds_write_b128 v37, v[112:115] offset:2048
    s_barrier
    ds_write_b128 v37, v[116:119] offset:3072
    ds_write_b128 v37, v[120:123] offset:4096
    ds_read_b64_tr_b16 v[40:41], v38 offset:0
    ds_read_b64_tr_b16 v[42:43], v38 offset:1280
    ds_read_b64_tr_b16 v[44:45], v38 offset:8
    ds_read_b64_tr_b16 v[46:47], v38 offset:1288
    ds_read_b64_tr_b16 v[48:49], v38 offset:16
    ds_read_b64_tr_b16 v[50:51], v38 offset:1296
    ds_read_b64_tr_b16 v[52:53], v38 offset:24
    ds_read_b64_tr_b16 v[54:55], v38 offset:1304
    ds_read_b64_tr_b16 v[56:57], v38 offset:32
    ds_read_b64_tr_b16 v[58:59], v38 offset:1312
    s_waitcnt lgkmcnt(8)
    s_add_u32 s95, s90, 0
    buffer_store_dwordx4 v[40:43], v39, s[36:39], s95 offen sc1
    s_waitcnt lgkmcnt(6)
    s_add_u32 s95, s90, 49152
    buffer_store_dwordx4 v[44:47], v39, s[36:39], s95 offen sc1
    s_waitcnt lgkmcnt(4)
    s_add_u32 s95, s90, 98304
    buffer_store_dwordx4 v[48:51], v39, s[36:39], s95 offen sc1
    s_waitcnt lgkmcnt(2)
    s_add_u32 s95, s90, 147456
    buffer_store_dwordx4 v[52:55], v39, s[36:39], s95 offen sc1
    s_waitcnt lgkmcnt(0)
    s_barrier
    s_add_u32 s95, s90, 196608
    buffer_store_dwordx4 v[56:59], v39, s[36:39], s95 offen sc1
    s_waitcnt vmcnt(0)
    v_mov_b32 v40, 1
    v_mov_b32 v41, 0
    s_lshl_b32 s94, s99, 2
    s_add_u32 s94, s94, 13783040
    s_mov_b64 s[92:93], exec
    s_mov_b64 exec, 1
    buffer_store_dword v40, v41, s[36:39], s94 offen sc1
    s_mov_b64 exec, s[92:93]
    s_barrier
    s_barrier
    s_barrier
    s_barrier
    s_barrier
    s_branch Lmain_end
Lrole_l:
    s_mov_b32 s40, s84
    s_and_b32 s41, s85, 0xffff
    s_mov_b32 s42, 256
    s_mov_b32 s43, 0x20000
    s_mov_b32 s44, s46
    s_and_b32 s45, s47, 0xffff
    s_mov_b32 s46, 2621440
    s_mov_b32 s47, 0x20000
    v_lshlrev_b32 v12, 21, v11
    v_cmp_gt_u32 vcc, 7, v11
    s_and_saveexec_b64 s[48:49], vcc
    buffer_load_dword v13, v12, s[36:39], 0 offen
    s_mov_b64 exec, s[48:49]
    v_lshlrev_b32 v12, 20, v11
    v_cmp_gt_u32 vcc, 3, v11
    s_and_saveexec_b64 s[48:49], vcc
    buffer_load_dword v14, v12, s[44:47], 0 offen
    s_mov_b64 exec, s[48:49]
    s_mov_b32 s98, 143360
    v_mov_b32 v248, 0
    v_mov_b32 v249, 0
    s_lshl_b32 s94, s2, 2
    s_add_u32 s72, s94, 13778944
    s_sub_u32 s94, s21, 16
    s_lshl_b32 s94, s94, 3
    s_add_u32 s94, s94, s20
    s_and_b32 s95, s2, 127
    s_add_u32 s95, s95, 128
    s_cmp_ge_u32 s21, 16
    s_cselect_b32 s94, s94, s95
    s_lshl_b32 s94, s94, 2
    s_add_u32 s96, s94, 13783040
    s_lshl_b32 s94, s22, 4
    s_add_u32 s94, s94, s23
    s_lshl_b32 s94, s94, 7
    s_add_u32 s97, s94, 13787136
    s_lshl_b32 s94, s20, 5
    s_add_u32 s94, s94, s21
    s_lshl_b32 s94, s94, 7
    s_add_u32 s94, s94, 13721600
    s_sub_u32 s95, 3, s101
    v_mov_b32 v252, 0
    v_mov_b32 v253, 0
    v_mov_b32 v254, s95
    v_mov_b32 v255, 0
    s_mov_b64 s[92:93], exec
    s_mov_b64 exec, 1
    buffer_store_dword v248, v249, s[36:39], s72 offen sc1
    buffer_store_dword v248, v249, s[36:39], s96 offen sc1
    buffer_store_dword v248, v249, s[36:39], s97 offen sc1
    s_add_u32 s95, s72, 49152
    buffer_store_dword v248, v249, s[36:39], s95 offen sc1
    buffer_store_dwordx4 v[252:255], v249, s[36:39], s94 offen sc1
    s_mov_b64 exec, s[92:93]
    v_lshrrev_b32 v227, 4, v11
    v_bfe_u32 v226, v11, 2, 2
    v_and_b32 v228, 3, v11
    v_lshl_add_u32 v226, v227, 3, v226
    v_mov_b32 v216, 0x3f803f80
    v_mul_u32_u24 v226, 192, v226
    v_mov_b32 v217, 0x3f803f80
    v_lshl_add_u32 v226, v228, 3, v226
    v_mov_b32 v218, 0x3f803f80
    v_add_u32 v220, 49152, v226
    v_mov_b32 v219, 0x3f803f80
    s_barrier
    ds_read_b64_tr_b16 v[72:73], v220 offset:0
    ds_read_b64_tr_b16 v[74:75], v220 offset:768
    ds_read_b64_tr_b16 v[76:77], v220 offset:32
    ds_read_b64_tr_b16 v[78:79], v220 offset:800
    ds_read_b64_tr_b16 v[80:81], v220 offset:64
    ds_read_b64_tr_b16 v[82:83], v220 offset:832
    ds_read_b64_tr_b16 v[84:85], v220 offset:96
    ds_read_b64_tr_b16 v[86:87], v220 offset:864
    ds_read_b64_tr_b16 v[88:89], v220 offset:128
    ds_read_b64_tr_b16 v[90:91], v220 offset:896
    ds_read_b64_tr_b16 v[92:93], v220 offset:160
    ds_read_b64_tr_b16 v[94:95], v220 offset:928
    ds_read_b64_tr_b16 v[96:97], v220 offset:12320
    ds_read_b64_tr_b16 v[98:99], v220 offset:13088
    ds_read_b64_tr_b16 v[100:101], v220 offset:12352
    ds_read_b64_tr_b16 v[102:103], v220 offset:13120
    ds_read_b64_tr_b16 v[104:105], v220 offset:12384
    ds_read_b64_tr_b16 v[106:107], v220 offset:13152
    ds_read_b64_tr_b16 v[108:109], v220 offset:12416
    ds_read_b64_tr_b16 v[110:111], v220 offset:13184
    ds_read_b64_tr_b16 v[112:113], v220 offset:12448
    ds_read_b64_tr_b16 v[114:115], v220 offset:13216
    ds_read_b64_tr_b16 v[116:117], v220 offset:12480
    ds_read_b64_tr_b16 v[118:119], v220 offset:13248
    ds_read_b64_tr_b16 v[120:121], v220 offset:6144
    ds_read_b64_tr_b16 v[122:123], v220 offset:6912
    ds_read_b64_tr_b16 v[124:125], v220 offset:6176
    ds_read_b64_tr_b16 v[126:127], v220 offset:6944
    ds_read_b64_tr_b16 v[128:129], v220 offset:6208
    ds_read_b64_tr_b16 v[130:131], v220 offset:6976
    ds_read_b64_tr_b16 v[132:133], v220 offset:6240
    ds_read_b64_tr_b16 v[134:135], v220 offset:7008
    ds_read_b64_tr_b16 v[136:137], v220 offset:6272
    ds_read_b64_tr_b16 v[138:139], v220 offset:7040
    ds_read_b64_tr_b16 v[140:141], v220 offset:6304
    ds_read_b64_tr_b16 v[142:143], v220 offset:7072
    ds_read_b64_tr_b16 v[144:145], v220 offset:18464
    ds_read_b64_tr_b16 v[146:147], v220 offset:19232
    ds_read_b64_tr_b16 v[148:149], v220 offset:18496
    ds_read_b64_tr_b16 v[150:151], v220 offset:19264
    ds_read_b64_tr_b16 v[152:153], v220 offset:18528
    ds_read_b64_tr_b16 v[154:155], v220 offset:19296
    ds_read_b64_tr_b16 v[156:157], v220 offset:18560
    ds_read_b64_tr_b16 v[158:159], v220 offset:19328
    ds_read_b64_tr_b16 v[160:161], v220 offset:18592
    ds_read_b64_tr_b16 v[162:163], v220 offset:19360
    ds_read_b64_tr_b16 v[164:165], v220 offset:18624
    ds_read_b64_tr_b16 v[166:167], v220 offset:19392
    s_waitcnt lgkmcnt(0)
    s_waitcnt vmcnt(0)
    s_and_b32 s94, s2, 1
    s_lshl_b32 s94, s94, 7
    v_mov_b32 v250, 1
    v_mov_b32 v249, 0
    s_mov_b64 s[92:93], exec
    s_mov_b64 exec, 1
    buffer_atomic_add v250, v249, s[40:43], s94 offen sc1
    s_mov_b64 exec, s[92:93]
    s_barrier
    s_setprio 1
    v_mfma_f32_16x16x32_bf16 v[168:171], v[72:75], v[216:219], 0
    v_mfma_f32_16x16x32_bf16 v[172:175], v[76:79], v[216:219], 0
    v_mfma_f32_16x16x32_bf16 v[176:179], v[80:83], v[216:219], 0
    v_mfma_f32_16x16x32_bf16 v[180:183], v[84:87], v[216:219], 0
    v_mfma_f32_16x16x32_bf16 v[184:187], v[88:91], v[216:219], 0
    v_mfma_f32_16x16x32_bf16 v[188:191], v[92:95], v[216:219], 0
    v_mfma_f32_16x16x32_bf16 v[192:195], v[96:99], v[216:219], 0
    v_mfma_f32_16x16x32_bf16 v[196:199], v[100:103], v[216:219], 0
    v_mfma_f32_16x16x32_bf16 v[200:203], v[104:107], v[216:219], 0
    v_mfma_f32_16x16x32_bf16 v[204:207], v[108:111], v[216:219], 0
    v_mfma_f32_16x16x32_bf16 v[208:211], v[112:115], v[216:219], 0
    v_mfma_f32_16x16x32_bf16 v[212:215], v[116:119], v[216:219], 0
    s_setprio 0
    s_setprio 1
    v_mfma_f32_16x16x32_bf16 v[168:171], v[120:123], v[216:219], v[168:171]
    v_mfma_f32_16x16x32_bf16 v[172:175], v[124:127], v[216:219], v[172:175]
    v_mfma_f32_16x16x32_bf16 v[176:179], v[128:131], v[216:219], v[176:179]
    v_mfma_f32_16x16x32_bf16 v[180:183], v[132:135], v[216:219], v[180:183]
    v_mfma_f32_16x16x32_bf16 v[184:187], v[136:139], v[216:219], v[184:187]
    v_mfma_f32_16x16x32_bf16 v[188:191], v[140:143], v[216:219], v[188:191]
    v_mfma_f32_16x16x32_bf16 v[192:195], v[144:147], v[216:219], v[192:195]
    v_mfma_f32_16x16x32_bf16 v[196:199], v[148:151], v[216:219], v[196:199]
    v_mfma_f32_16x16x32_bf16 v[200:203], v[152:155], v[216:219], v[200:203]
    v_mfma_f32_16x16x32_bf16 v[204:207], v[156:159], v[216:219], v[204:207]
    v_mfma_f32_16x16x32_bf16 v[208:211], v[160:163], v[216:219], v[208:211]
    v_mfma_f32_16x16x32_bf16 v[212:215], v[164:167], v[216:219], v[212:215]
    s_setprio 0
    v_and_b32 v236, 7, v11
    v_lshlrev_b32 v236, 3, v236
    v_add_u32 v237, 154432, v236
    s_lshl_b32 s95, s2, 6
    s_add_u32 s95, s95, 13500416
    ds_read_b64 v[238:239], v237
    s_waitcnt lgkmcnt(0)
    s_mov_b64 s[92:93], exec
    s_mov_b64 exec, 0xff
    buffer_store_dwordx2 v[238:239], v236, s[36:39], s95 offen sc1
    s_mov_b64 exec, s[92:93]
    v_lshrrev_b32 v226, 4, v11
    v_lshlrev_b32 v227, 4, v11
    v_lshlrev_b32 v226, 4, v226
    v_add_u32 v228, 123648, v227
    v_add_u32 v226, 123648, v226
    s_mul_i32 s94, s23, 12288
    s_mul_i32 s95, s22, 768
    s_add_u32 s94, s94, s95
    s_add_u32 s94, s94, 13516800
    s_mov_b64 s[92:93], exec
    s_mov_b32 exec_lo, 0x00010001
    s_mov_b32 exec_hi, 0x00010001
    ds_write_b128 v226, v[168:171] offset:0
    ds_write_b128 v226, v[172:175] offset:64
    ds_write_b128 v226, v[176:179] offset:128
    ds_write_b128 v226, v[180:183] offset:192
    ds_write_b128 v226, v[184:187] offset:256
    ds_write_b128 v226, v[188:191] offset:320
    ds_write_b128 v226, v[192:195] offset:384
    ds_write_b128 v226, v[196:199] offset:448
    ds_write_b128 v226, v[200:203] offset:512
    ds_write_b128 v226, v[204:207] offset:576
    ds_write_b128 v226, v[208:211] offset:640
    ds_write_b128 v226, v[212:215] offset:704
    s_mov_b32 exec_lo, -1
    s_mov_b32 exec_hi, 0xffff
    ds_read_b128 v[72:75], v228
    s_waitcnt lgkmcnt(0)
    buffer_store_dwordx4 v[72:75], v227, s[36:39], s94 offen sc1
    s_mov_b64 exec, s[92:93]
    s_barrier
    v_bfe_u32 v232, v11, 2, 2
    v_lshrrev_b32 v233, 4, v11
    v_mul_u32_u24 v232, 1344, v232
    v_lshl_add_u32 v232, v233, 5, v232
    v_and_b32 v233, 3, v11
    v_lshl_add_u32 v232, v233, 3, v232
    v_add_u32 v232, s98, v232
    ds_read_b64_tr_b16 v[32:33], v232 offset:0
    ds_read_b64_tr_b16 v[34:35], v232 offset:5376
    ds_read_b64_tr_b16 v[36:37], v232 offset:128
    ds_read_b64_tr_b16 v[38:39], v232 offset:5504
    ds_read_b64_tr_b16 v[40:41], v232 offset:256
    ds_read_b64_tr_b16 v[42:43], v232 offset:5632
    ds_read_b64_tr_b16 v[44:45], v232 offset:384
    ds_read_b64_tr_b16 v[46:47], v232 offset:5760
    ds_read_b64_tr_b16 v[48:49], v232 offset:512
    ds_read_b64_tr_b16 v[50:51], v232 offset:5888
    ds_read_b64_tr_b16 v[52:53], v232 offset:640
    ds_read_b64_tr_b16 v[54:55], v232 offset:6016
    ds_read_b64_tr_b16 v[56:57], v232 offset:768
    ds_read_b64_tr_b16 v[58:59], v232 offset:6144
    ds_read_b64_tr_b16 v[60:61], v232 offset:896
    ds_read_b64_tr_b16 v[62:63], v232 offset:6272
    ds_read_b64_tr_b16 v[64:65], v232 offset:1024
    ds_read_b64_tr_b16 v[66:67], v232 offset:6400
    ds_read_b64_tr_b16 v[68:69], v232 offset:1152
    ds_read_b64_tr_b16 v[70:71], v232 offset:6528
    s_waitcnt lgkmcnt(0)
    s_waitcnt vmcnt(0)
    v_mov_b32 v250, 1
    v_mov_b32 v249, 0
    s_add_u32 s94, s72, 0
    s_mov_b64 s[92:93], exec
    s_mov_b64 exec, 1
    buffer_store_dword v250, v249, s[36:39], s94 offen sc1
    s_mov_b64 exec, s[92:93]
    v_lshlrev_b32 v235, 4, v11
    s_mul_i32 s94, s2, 10240
    s_add_u32 s94, s94, 6291456
    buffer_store_dwordx4 v[32:35], v235, s[36:39], s94 offen offset:0 sc1
    buffer_store_dwordx4 v[36:39], v235, s[36:39], s94 offen offset:1024 sc1
    buffer_store_dwordx4 v[40:43], v235, s[36:39], s94 offen offset:2048 sc1
    buffer_store_dwordx4 v[44:47], v235, s[36:39], s94 offen offset:3072 sc1
    s_add_u32 s94, s94, 4096
    buffer_store_dwordx4 v[48:51], v235, s[36:39], s94 offen offset:0 sc1
    s_barrier
    buffer_store_dwordx4 v[52:55], v235, s[36:39], s94 offen offset:1024 sc1
    buffer_store_dwordx4 v[56:59], v235, s[36:39], s94 offen offset:2048 sc1
    buffer_store_dwordx4 v[60:63], v235, s[36:39], s94 offen offset:3072 sc1
    s_add_u32 s94, s94, 4096
    buffer_store_dwordx4 v[64:67], v235, s[36:39], s94 offen offset:0 sc1
    buffer_store_dwordx4 v[68:71], v235, s[36:39], s94 offen offset:1024 sc1
    s_barrier
    s_waitcnt vmcnt(0)
    v_mov_b32 v250, 1
    v_mov_b32 v249, 0
    s_add_u32 s94, s72, 49152
    s_mov_b64 s[92:93], exec
    s_mov_b64 exec, 1
    buffer_store_dword v250, v249, s[36:39], s94 offen sc1
    s_mov_b64 exec, s[92:93]
    s_barrier
    s_barrier
    v_and_b32 v32, 1, v11
    v_lshlrev_b32 v32, 7, v32
    buffer_load_dword v33, v32, s[40:43], 0 offen sc1
    s_barrier
    s_waitcnt vmcnt(0)
    s_mov_b32 s82, 0
Lspclr:
    v_cmp_eq_u32 vcc, 128, v33
    s_nop 1
    s_cmp_eq_u64 vcc, exec
    s_cbranch_scc1 Lspokclr
    s_add_u32 s82, s82, 1
    s_cmp_gt_u32 s82, 1048576
    s_cbranch_scc1 Lmain_end
    s_sleep 3
    buffer_load_dword v33, v32, s[40:43], 0 offen sc1
    s_waitcnt vmcnt(0)
    s_branch Lspclr
Lspokclr:
    v_lshlrev_b32 v34, 4, v11
    v_and_b32 v35, 15, v11
    v_lshlrev_b32 v35, 2, v35
    s_lshl_b32 s94, s3, 6
    s_add_u32 s97, s94, 13783040
    s_mov_b32 s96, 13778944
    buffer_load_dwordx4 v[36:39], v34, s[36:39], s96 offen sc1
    buffer_load_dword v40, v35, s[36:39], s97 offen sc1
    s_barrier
    s_waitcnt vmcnt(0)
    s_mov_b32 s82, 0
Lspfl:
    v_and_b32 v41, v36, v37
    v_and_b32 v42, v38, v39
    v_and_b32 v41, v41, v42
    v_and_b32 v41, v41, v40
    v_cmp_eq_u32 vcc, 1, v41
    s_nop 1
    s_cmp_eq_u64 vcc, exec
    s_cbranch_scc1 Lspokfl
    s_add_u32 s82, s82, 1
    s_cmp_gt_u32 s82, 1048576
    s_cbranch_scc1 Lmain_end
    s_sleep 3
    buffer_load_dwordx4 v[36:39], v34, s[36:39], s96 offen sc1
    buffer_load_dword v40, v35, s[36:39], s97 offen sc1
    s_waitcnt vmcnt(0)
    s_branch Lspfl
Lspokfl:
    v_lshlrev_b32 v39, 4, v11
    s_lshl_b32 s94, s22, 10
    s_add_u32 s94, s94, 13500416
    s_mul_i32 s95, s23, 12288
    s_add_u32 s95, s95, 13516800
    buffer_load_dwordx4 v[40:43], v39, s[36:39], s94 offen sc1
    s_add_u32 s96, s95, 0
    buffer_load_dwordx4 v[44:47], v39, s[36:39], s96 offen sc1
    s_add_u32 s96, s95, 768
    buffer_load_dwordx4 v[48:51], v39, s[36:39], s96 offen sc1
    s_add_u32 s96, s95, 1536
    buffer_load_dwordx4 v[52:55], v39, s[36:39], s96 offen sc1
    s_add_u32 s96, s95, 2304
    buffer_load_dwordx4 v[56:59], v39, s[36:39], s96 offen sc1
    s_add_u32 s96, s95, 3072
    buffer_load_dwordx4 v[60:63], v39, s[36:39], s96 offen sc1
    s_add_u32 s96, s95, 3840
    buffer_load_dwordx4 v[64:67], v39, s[36:39], s96 offen sc1
    s_add_u32 s96, s95, 4608
    buffer_load_dwordx4 v[68:71], v39, s[36:39], s96 offen sc1
    s_add_u32 s96, s95, 5376
    buffer_load_dwordx4 v[72:75], v39, s[36:39], s96 offen sc1
    s_add_u32 s96, s95, 6144
    buffer_load_dwordx4 v[76:79], v39, s[36:39], s96 offen sc1
    s_add_u32 s96, s95, 6912
    buffer_load_dwordx4 v[80:83], v39, s[36:39], s96 offen sc1
    s_barrier
    s_waitcnt vmcnt(0)
    v_add_f32 v44, v44, v48
    v_add_f32 v45, v45, v49
    v_add_f32 v46, v46, v50
    v_add_f32 v47, v47, v51
    v_add_f32 v44, v44, v52
    v_add_f32 v45, v45, v53
    v_add_f32 v46, v46, v54
    v_add_f32 v47, v47, v55
    v_add_f32 v44, v44, v56
    v_add_f32 v45, v45, v57
    v_add_f32 v46, v46, v58
    v_add_f32 v47, v47, v59
    v_add_f32 v44, v44, v60
    v_add_f32 v45, v45, v61
    v_add_f32 v46, v46, v62
    v_add_f32 v47, v47, v63
    v_add_f32 v44, v44, v64
    v_add_f32 v45, v45, v65
    v_add_f32 v46, v46, v66
    v_add_f32 v47, v47, v67
    v_add_f32 v44, v44, v68
    v_add_f32 v45, v45, v69
    v_add_f32 v46, v46, v70
    v_add_f32 v47, v47, v71
    v_add_f32 v44, v44, v72
    v_add_f32 v45, v45, v73
    v_add_f32 v46, v46, v74
    v_add_f32 v47, v47, v75
    v_add_f32 v44, v44, v76
    v_add_f32 v45, v45, v77
    v_add_f32 v46, v46, v78
    v_add_f32 v47, v47, v79
    v_add_f32 v44, v44, v80
    v_add_f32 v45, v45, v81
    v_add_f32 v46, v46, v82
    v_add_f32 v47, v47, v83
    v_add_u32 v38, 123648, v39
    v_add_u32 v37, 124672, v39
    ds_write_b128 v38, v[40:43]
    s_mov_b64 s[92:93], exec
    s_mov_b32 exec_lo, -1
    s_mov_b32 exec_hi, 0xffff
    ds_write_b128 v37, v[44:47]
    s_mov_b64 exec, s[92:93]
    s_waitcnt lgkmcnt(0)
    s_barrier
Lmain_end:
    s_endpgm
.section .rodata,"a"
.p2align 6
.amdhsa_kernel parallel_sum__ssm_conv_s4d__glu_gated_swiglu__prompt_kernel
  .amdhsa_next_free_vgpr 256
  .amdhsa_next_free_sgpr 102
  .amdhsa_accum_offset 256
  .amdhsa_group_segment_fixed_size 0
  .amdhsa_kernarg_size 112
  .amdhsa_user_sgpr_count 2
  .amdhsa_user_sgpr_kernarg_segment_ptr 1
  .amdhsa_system_sgpr_workgroup_id_x 1
  .amdhsa_float_denorm_mode_32 3
.end_amdhsa_kernel
```
